```python
import torch

def _softmax(x, axis=-1):
    return torch.softmax(x, dim=axis)
def _gelu(x):
    return torch.nn.functional.gelu(x, approximate="tanh")
def _silu(x):
    return torch.nn.functional.silu(x)
def _sigmoid(x):
    return torch.sigmoid(x)
def _layernorm(x, axis=-1, eps=1e-5):
    m = x.mean(dim=axis, keepdim=True)
    v = x.var(dim=axis, keepdim=True, unbiased=False)
    return (x - m) / torch.sqrt(v + eps)
def _scatter_add(tgt, idx, src, axis=0):
    return tgt.clone().index_add_(axis, idx, src)
def _segment_sum(src, seg, n):
    out = torch.zeros((n,) + src.shape[1:], dtype=src.dtype)
    return out.index_add_(0, seg, src)
def _pad(x, pw):
    flat = tuple(v for pair in reversed(pw) for v in pair)
    return torch.nn.functional.pad(x, flat)

kernel_name = 'gated_mix__softmax_full_mha__dense_activation_silu__prompt'

def setup_inputs():

    _w = (lambda a: (lambda t: t.to(torch.bfloat16) if t.is_floating_point() else t)(torch.as_tensor(a)))
    def _A_setup():
        B, S, D = 1, 2048, 640
        return {
            "x": _w((lambda *s: torch.randn(*s, dtype=torch.bfloat16) * 0.1)(B, S, D)),
            "wqkv": _w((lambda *s: torch.randn(*s, dtype=torch.bfloat16) * 0.4)(D, 3 * D)),
            "wo": _w((lambda *s: torch.randn(*s, dtype=torch.bfloat16) * 0.2)(D, D)),
        }
    _A_in = _A_setup()

    def _B_setup():
        B, S, D, F = 1, 2048, 640, 1536
        return {
            "x": _w((lambda *s: torch.randn(*s, dtype=torch.bfloat16) * 0.1)(B, S, D)),
            "w1": _w((lambda *s: torch.randn(*s, dtype=torch.bfloat16) * 3.2)(D, F) * (D ** -0.5)),
            "w2": _w((lambda *s: torch.randn(*s, dtype=torch.bfloat16) * 3.2)(F, D) * (F ** -0.5)),
        }
    _B_in = _B_setup()

    return {
        "A_x": _A_in["x"],
        "A_wqkv": _A_in["wqkv"],
        "A_wo": _A_in["wo"],
        "B_x": _B_in["x"],
        "B_w1": _B_in["w1"],
        "B_w2": _B_in["w2"],
        "gate_w": _w((lambda *s: torch.randn(*s, dtype=torch.bfloat16) * 0.1)(640) * 16.0),
    }

def reference(A_x, A_wqkv, A_wo, B_x, B_w1, B_w2, gate_w):
    def _A_ref(x, wqkv, wo):
        B, S, D = x.shape
        H = 32; Dh = D // H
        qkv = (lambda x, *d: x.permute(*d))((x @ wqkv).reshape(B, S, 3, H, Dh), 2, 0, 3, 1, 4)
        q, k, v = qkv[0], qkv[1], qkv[2]
        scale = Dh ** -0.5
        scores = torch.einsum("bhqd,bhkd->bhqk", q, k) * scale
        p = _softmax(scores, axis=-1)
        o = torch.einsum("bhqk,bhkd->bhqd", p, v)
        return (lambda x, *d: x.permute(*d))(o, 0, 2, 1, 3).reshape(B, S, D) @ wo

    def _B_ref(x, w1, w2):
        h = torch.einsum("bsd,df->bsf", x, w1)
        h = _silu(h)
        out = torch.einsum("bsf,fd->bsd", h, w2)
        return out

    x = A_x
    g = _sigmoid((x * gate_w).sum(-1, keepdims=True))
    a = _A_ref(x, A_wqkv, A_wo)
    b = _B_ref(x, B_w1, B_w2)
    return g * a + (1 - g) * b
```

```asm
; @launch kernel=fused_kernel grid=(256,1,1) block=(768,1,1) lds=163840
.amdgcn_target "amdgcn-amd-amdhsa--gfx950"
.text
.globl fused_kernel
.p2align 8
.type fused_kernel,@function
fused_kernel:
    s_cmp_ge_u32 s2, 256
    s_cbranch_scc1 KF_END
    s_load_dwordx16 s[16:31], s[0:1], 0
    s_load_dwordx4 s[32:35], s[0:1], 64
    v_lshrrev_b32 v2, 6, v0
    v_and_b32 v0, 63, v0
    s_lshr_b32 s7, s2, 3
    v_readfirstlane_b32 s3, v2
    s_bfe_u32 s4, s2, 0x20004
    s_lshl_b32 s4, s4, 1
    s_and_b32 s8, s2, 1
    s_add_u32 s4, s4, s8
    s_lshl_b32 s4, s4, 1
    s_and_b32 s8, s7, 1
    s_add_u32 s4, s4, s8
    s_bfe_u32 s5, s2, 0x20001
    s_lshl_b32 s5, s5, 2
    s_lshr_b32 s8, s2, 6
    s_add_u32 s5, s5, s8
    s_lshl_b32 s5, s5, 2
    s_mov_b32 s8, 0x87625f10
    s_mov_b32 s9, 0xedc4ba93
    s_lshr_b64 s[8:9], s[8:9], s5
    s_and_b32 s5, s8, 15
    s_mov_b32 s39, 0x00020000
    s_mov_b32 s43, 0x00020000
    s_mov_b32 s47, 0x00020000
    s_mov_b32 s51, 0x00020000
    s_mov_b32 s55, 0x00020000
    s_mov_b32 s59, 0x00020000
    s_mov_b32 s63, 0x00020000
    s_mov_b32 s38, 0x10000000
    s_mov_b32 s42, 2621440
    s_mov_b32 s46, 2621440
    s_mov_b32 s54, 1966080
    s_mov_b32 s62, 256
    v_lshlrev_b32 v2, 4, v0
    v_and_b32 v3, 31, v0
    v_lshrrev_b32 v4, 5, v0
    s_sub_u32 s3, s3, 4
    s_cbranch_scc1 KF_LOADER
    s_cmp_ge_u32 s3, 2
    s_cbranch_scc1 KF_COMPUTE
    s_getpc_b64 s[70:71]
KF_PC:
    s_add_u32 s10, s7, s3
    s_and_b32 s10, s10, 7
    s_sub_u32 s70, s70, KF_PC-fused_kernel
    s_subb_u32 s71, s71, 0
    s_lshl_b32 s10, s10, 13
    v_lshl_add_u32 v5, v0, 7, s10
    v_min_u32 v5, KF_LAST-fused_kernel, v5
    global_load_dword v164, v5, s[70:71]
    s_branch KF_COMPUTE
KF_LOADER:
    s_add_u32 s3, s3, 12
    s_and_b32 s8, s7, 7
    s_mul_i32 s8, s8, 5
    s_lshr_b32 s8, s8, 2
    s_lshr_b32 s9, s7, 3
    s_mul_i32 s9, s9, 5
    s_lshr_b32 s9, s9, 1
    s_add_u32 s8, s8, s9
    s_sub_u32 s9, s8, 10
    s_cmp_ge_u32 s8, 10
    s_cselect_b32 s8, s9, s8
    s_sub_u32 s9, s5, 5
    s_cmp_lt_u32 s5, 5
    s_cselect_b32 s9, s5, s9
    s_mov_b32 s12, 0x76543210
    s_mov_b32 s13, 0xfedcba98
    s_cmp_eq_u32 s9, 0
    s_cmov_b32 s12, 0x72654310
    s_cmov_b32 s13, 0xfcedba98
    s_cmp_eq_u32 s9, 1
    s_cmov_b32 s12, 0x61875432
    s_cmov_b32 s13, 0xbfedca9
    s_cmp_eq_u32 s9, 2
    s_cmov_b32 s12, 0x50764321
    s_cmov_b32 s13, 0xfaedcb98
    s_cmp_eq_u32 s9, 3
    s_cmov_b32 s12, 0x94653210
    s_cmov_b32 s13, 0xfedcba87
    s_cmp_eq_u32 s9, 4
    s_cmov_b32 s12, 0x83765421
    s_cmov_b32 s13, 0xdfecba9
    s_sub_u32 s7, s3, 8
    s_lshl_b32 s64, s7, 12
    s_lshl_b32 s65, s7, 10
    s_cmp_eq_u32 s5, 15
    s_mov_b32 s69, 245760
    s_cmov_b32 s69, 128
    s_lshl_b32 s66, s8, 7
    s_mul_i32 s67, s8, s69
    s_mul_i32 s68, s8, 196608
    v_lshrrev_b32 v5, 3, v0
    v_and_b32 v6, 7, v0
    v_lshrrev_b32 v7, 4, v0
    v_xor_b32 v6, v6, v7
    s_lshl_b32 s9, s4, 7
    s_lshl_b32 s10, s7, 5
    s_add_u32 s9, s9, s10
    v_add_u32 v5, s9, v5
    v_mul_u32_u24 v5, 1280, v5
    v_lshl_add_u32 v10, v6, 4, v5
    v_xor_b32 v6, 4, v6
    v_lshl_add_u32 v11, v6, 4, v5
    v_add_u32 v11, 10240, v11
    v_add_u32 v12, 20480, v10
    v_add_u32 v13, 20480, v11
    v_and_b32 v6, 15, v0
    v_lshlrev_b32 v5, 2, v7
    v_xor_b32 v6, v6, v5
    v_lshlrev_b32 v5, 2, v6
    v_lshrrev_b64 v[22:23], v5, s[12:13]
    s_lshl_b32 s9, s7, 4
    v_add_u32 v7, s9, v7
    v_and_b32 v22, 15, v22
    s_lshl_b32 s9, s5, 8
    s_cmp_eq_u32 s5, 15
    s_cselect_b64 s[10:11], -1, 0
    v_mov_b32 v21, 0x40000000
    v_add_u32 v5, 0, v7
    v_mul_u32_u24 v8, 3840, v5
    v_lshl_add_u32 v8, v22, 4, v8
    v_add_u32 v8, s9, v8
    v_and_b32 v9, 7, v5
    v_cmp_eq_u32 vcc, v9, v6
    v_lshrrev_b32 v9, 3, v5
    v_lshlrev_b32 v9, 4, v9
    v_cndmask_b32 v9, v21, v9, vcc
    v_cndmask_b32 v14, v8, v9, s[10:11]
    v_add_u32 v5, 4, v7
    v_mul_u32_u24 v8, 3840, v5
    v_lshl_add_u32 v8, v22, 4, v8
    v_add_u32 v8, s9, v8
    v_and_b32 v9, 7, v5
    v_cmp_eq_u32 vcc, v9, v6
    v_lshrrev_b32 v9, 3, v5
    v_lshlrev_b32 v9, 4, v9
    v_cndmask_b32 v9, v21, v9, vcc
    v_cndmask_b32 v15, v8, v9, s[10:11]
    v_add_u32 v5, 8, v7
    v_mul_u32_u24 v8, 3840, v5
    v_lshl_add_u32 v8, v22, 4, v8
    v_add_u32 v8, s9, v8
    v_and_b32 v9, 7, v5
    v_cmp_eq_u32 vcc, v9, v6
    v_lshrrev_b32 v9, 3, v5
    v_lshlrev_b32 v9, 4, v9
    v_cndmask_b32 v9, v21, v9, vcc
    v_cndmask_b32 v16, v8, v9, s[10:11]
    v_add_u32 v5, 12, v7
    v_mul_u32_u24 v8, 3840, v5
    v_lshl_add_u32 v8, v22, 4, v8
    v_add_u32 v8, s9, v8
    v_and_b32 v9, 7, v5
    v_cmp_eq_u32 vcc, v9, v6
    v_lshrrev_b32 v9, 3, v5
    v_lshlrev_b32 v9, 4, v9
    v_cndmask_b32 v9, v21, v9, vcc
    v_cndmask_b32 v17, v8, v9, s[10:11]
    s_waitcnt lgkmcnt(0)
    s_mov_b32 s44, s16
    s_mov_b32 s45, s17
    s_cmp_eq_u32 s5, 15
    s_cselect_b32 s48, s28, s18
    s_cselect_b32 s49, s29, s19
    s_mov_b32 s50, 2457600
    s_cmov_b32 s50, 1280
    s_add_u32 m0, s64, 32768
    s_nop 0
    buffer_load_dwordx4 v10, s[44:47], s66 offen lds
    s_add_u32 m0, s64, 49152
    s_nop 0
    buffer_load_dwordx4 v14, s[48:51], s67 offen lds
    s_add_u32 m0, s64, 33792
    s_nop 0
    buffer_load_dwordx4 v11, s[44:47], s66 offen lds
    s_add_u32 m0, s64, 50176
    s_nop 0
    buffer_load_dwordx4 v15, s[48:51], s67 offen lds
    s_add_u32 m0, s64, 34816
    s_nop 0
    buffer_load_dwordx4 v12, s[44:47], s66 offen lds
    s_add_u32 m0, s64, 51200
    s_nop 0
    buffer_load_dwordx4 v16, s[48:51], s67 offen lds
    s_add_u32 m0, s64, 35840
    s_nop 0
    buffer_load_dwordx4 v13, s[44:47], s66 offen lds
    s_add_u32 m0, s64, 52224
    s_nop 0
    buffer_load_dwordx4 v17, s[48:51], s67 offen lds
    s_add_u32 s66, s66, 128
    s_add_u32 s67, s67, s69
    s_cmp_eq_u32 s66, 1280
    s_cselect_b32 s66, 0, s66
    s_cselect_b32 s67, 0, s67
    s_add_u32 m0, s64, 0
    s_nop 0
    buffer_load_dwordx4 v10, s[44:47], s66 offen lds
    s_add_u32 m0, s64, 16384
    s_nop 0
    buffer_load_dwordx4 v14, s[48:51], s67 offen lds
    s_add_u32 m0, s64, 1024
    s_nop 0
    buffer_load_dwordx4 v11, s[44:47], s66 offen lds
    s_add_u32 m0, s64, 17408
    s_nop 0
    buffer_load_dwordx4 v15, s[48:51], s67 offen lds
    s_add_u32 m0, s64, 2048
    s_nop 0
    buffer_load_dwordx4 v12, s[44:47], s66 offen lds
    s_add_u32 m0, s64, 18432
    s_nop 0
    buffer_load_dwordx4 v16, s[48:51], s67 offen lds
    s_add_u32 m0, s64, 3072
    s_nop 0
    buffer_load_dwordx4 v13, s[44:47], s66 offen lds
    s_add_u32 m0, s64, 19456
    s_nop 0
    buffer_load_dwordx4 v17, s[48:51], s67 offen lds
    s_add_u32 s66, s66, 128
    s_add_u32 s67, s67, s69
    s_cmp_eq_u32 s66, 1280
    s_cselect_b32 s66, 0, s66
    s_cselect_b32 s67, 0, s67
    s_mov_b32 s52, s24
    s_mov_b32 s53, s25
    s_mov_b32 s36, s34
    s_mov_b32 s37, s35
    s_mov_b32 s40, s30
    s_mov_b32 s41, s31
    s_mov_b32 s60, s32
    s_mov_b32 s61, s33
    s_mul_i32 s9, s7, 24576
    s_mul_i32 s10, s5, 192
    s_add_u32 s9, s9, s10
    s_and_b32 s10, s5, 1
    s_lshl_b32 s10, s10, 6
    s_add_u32 s11, s9, s10
    s_lshl_b32 s10, s10, 1
    s_sub_u32 s9, s9, s10
    s_add_u32 s9, s9, 128
    v_lshrrev_b32 v5, 3, v0
    v_mul_u32_u24 v5, 3072, v5
    v_bfe_u32 v6, v0, 4, 1
    v_lshlrev_b32 v6, 2, v6
    v_and_b32 v7, 7, v0
    v_xor_b32 v6, v6, v7
    v_lshl_add_u32 v18, v6, 4, v5
    v_add_u32 v18, s11, v18
    v_lshrrev_b32 v7, 2, v6
    v_mul_u32_u24 v7, 98304, v7
    v_and_b32 v6, 3, v6
    v_lshl_add_u32 v20, v6, 4, v5
    v_add3_u32 v20, v20, v7, s9
    s_mul_i32 s8, s2, 3
    s_add_u32 s8, s8, s7
    s_sub_u32 s8, s8, 1
    s_mul_i32 s9, s8, 13108
    s_lshr_b32 s9, s9, 16
    s_mul_i32 s10, s9, 5
    s_sub_u32 s8, s8, s10
    s_sub_u32 s10, s9, 96
    s_and_b32 s10, s10, 63
    s_mul_i32 s11, s10, 6554
    s_lshr_b32 s11, s11, 16
    s_mul_i32 s12, s11, 10
    s_sub_u32 s12, s10, s12
    s_mul_i32 s11, s11, 160
    s_mul_i32 s13, s12, 20
    s_mul_i32 s14, s12, 80
    s_sub_u32 s14, s14, 624
    s_cmp_lt_u32 s12, 8
    s_cselect_b32 s13, s13, s14
    s_mov_b32 s70, 51200
    s_cmov_b32 s70, 5120
    s_mov_b32 s71, 25600
    s_cmov_b32 s71, 10240
    s_add_u32 s11, s11, s13
    s_lshl_b32 s12, s9, 4
    s_mul_i32 s10, s10, 5120
    s_add_u32 s10, s10, 0x1600000
    s_lshl_b32 s13, s9, 10
    s_add_u32 s13, s13, 0x1400000
    s_cmp_lt_u32 s9, 96
    s_cselect_b32 s56, s26, s20
    s_cselect_b32 s57, s27, s21
    s_mov_b32 s58, 819200
    s_cmov_b32 s58, 1966080
    s_cmov_b32 s70, 5120
    s_cmov_b32 s71, 10240
    s_cselect_b32 s11, s12, s11
    s_cselect_b32 s10, s13, s10
    s_mov_b32 s12, 1024
    s_cmov_b32 s12, 98304
    s_cselect_b32 s13, 0, 199680
    s_mul_i32 s11, s11, 1280
    s_lshl_b32 s14, s8, 8
    s_add_u32 s11, s11, s14
    s_cmp_lt_u32 s9, 136
    s_cselect_b32 s11, s11, 0x40000000
    s_cselect_b32 s10, s10, 0x40000000
    s_cmp_eq_u32 s7, 0
    s_cmov_b32 s11, 0x40000000
    s_cmov_b32 s10, 0x40000000
    v_lshrrev_b32 v5, 4, v0
    v_mul_u32_u24 v5, 1280, v5
    v_and_b32 v6, 15, v0
    v_lshl_add_u32 v5, v6, 4, v5
    v_add_u32 v22, s11, v5
    s_lshl_b32 s8, s8, 2
    s_mul_i32 s9, s8, 13108
    s_lshr_b32 s9, s9, 16
    s_mul_i32 s9, s9, s13
    s_mul_i32 s11, s8, s12
    s_add_u32 s9, s9, s11
    s_add_u32 s9, s9, s10
    v_add_u32 v30, s9, v2
    s_add_u32 s8, s8, 1
    s_mul_i32 s9, s8, 13108
    s_lshr_b32 s9, s9, 16
    s_mul_i32 s9, s9, s13
    s_mul_i32 s11, s8, s12
    s_add_u32 s9, s9, s11
    s_add_u32 s9, s9, s10
    v_add_u32 v31, s9, v2
    s_add_u32 s8, s8, 1
    s_mul_i32 s9, s8, 13108
    s_lshr_b32 s9, s9, 16
    s_mul_i32 s9, s9, s13
    s_mul_i32 s11, s8, s12
    s_add_u32 s9, s9, s11
    s_add_u32 s9, s9, s10
    v_add_u32 v32, s9, v2
    s_add_u32 s8, s8, 1
    s_mul_i32 s9, s8, 13108
    s_lshr_b32 s9, s9, 16
    s_mul_i32 s9, s9, s13
    s_mul_i32 s11, s8, s12
    s_add_u32 s9, s9, s11
    s_add_u32 s9, s9, s10
    v_add_u32 v33, s9, v2
    s_add_u32 s8, s8, 1
    v_bfe_u32 v5, v0, 2, 2
    v_lshlrev_b32 v5, 8, v5
    v_lshl_add_u32 v5, v4, 10, v5
    v_bfe_u32 v6, v0, 4, 1
    v_lshl_add_u32 v5, v6, 5, v5
    v_and_b32 v6, 3, v0
    v_lshl_add_u32 v5, v6, 3, v5
    s_add_u32 s8, s64, 131072
    v_add_u32 v23, s8, v5
    s_waitcnt vmcnt(8)
    s_barrier
    s_add_u32 m0, s64, 98304
    s_nop 0
    buffer_load_dwordx4 v10, s[44:47], s66 offen lds
    s_add_u32 m0, s64, 114688
    s_nop 0
    buffer_load_dwordx4 v14, s[48:51], s67 offen lds
    s_add_u32 m0, s64, 99328
    s_nop 0
    buffer_load_dwordx4 v11, s[44:47], s66 offen lds
    s_add_u32 m0, s64, 115712
    s_nop 0
    buffer_load_dwordx4 v15, s[48:51], s67 offen lds
    s_add_u32 m0, s64, 100352
    s_nop 0
    buffer_load_dwordx4 v12, s[44:47], s66 offen lds
    s_add_u32 m0, s64, 116736
    s_nop 0
    buffer_load_dwordx4 v16, s[48:51], s67 offen lds
    s_add_u32 m0, s64, 101376
    s_nop 0
    buffer_load_dwordx4 v13, s[44:47], s66 offen lds
    s_add_u32 m0, s64, 117760
    s_nop 0
    buffer_load_dwordx4 v17, s[48:51], s67 offen lds
    s_add_u32 s66, s66, 128
    s_add_u32 s67, s67, s69
    s_cmp_eq_u32 s66, 1280
    s_cselect_b32 s66, 0, s66
    s_cselect_b32 s67, 0, s67
    s_waitcnt vmcnt(8)
    s_barrier
    s_add_u32 m0, s64, 65536
    s_nop 0
    buffer_load_dwordx4 v10, s[44:47], s66 offen lds
    s_add_u32 m0, s64, 81920
    s_nop 0
    buffer_load_dwordx4 v14, s[48:51], s67 offen lds
    s_add_u32 m0, s64, 66560
    s_nop 0
    buffer_load_dwordx4 v11, s[44:47], s66 offen lds
    s_add_u32 m0, s64, 82944
    s_nop 0
    buffer_load_dwordx4 v15, s[48:51], s67 offen lds
    s_add_u32 m0, s64, 67584
    s_nop 0
    buffer_load_dwordx4 v12, s[44:47], s66 offen lds
    s_add_u32 m0, s64, 83968
    s_nop 0
    buffer_load_dwordx4 v16, s[48:51], s67 offen lds
    s_add_u32 m0, s64, 68608
    s_nop 0
    buffer_load_dwordx4 v13, s[44:47], s66 offen lds
    s_add_u32 m0, s64, 84992
    s_nop 0
    buffer_load_dwordx4 v17, s[48:51], s67 offen lds
    s_add_u32 s66, s66, 128
    s_add_u32 s67, s67, s69
    s_cmp_eq_u32 s66, 1280
    s_cselect_b32 s66, 0, s66
    s_cselect_b32 s67, 0, s67
    s_and_b32 s4, s2, 7
    s_lshl_b32 s4, s4, 2
    s_bfe_u32 s5, s2, 0x20003
    s_add_u32 s4, s4, s5
    s_mul_i32 s6, s4, 1280
    s_sub_u32 s9, 40960, s6
    s_add_u32 s6, s6, 0x300000
    s_mul_i32 s8, s4, 20
    v_add_u32 v5, -16, v0
    v_and_b32 v5, 0x7f, v5
    v_mul_u32_u24 v6, 3121, v5
    v_lshrrev_b32 v6, 16, v6
    v_mul_u32_u24 v7, 21, v6
    v_sub_u32 v5, v5, v7
    v_add_u32 v5, s8, v5
    v_lshrrev_b32 v7, 5, v5
    v_and_b32 v5, 31, v5
    v_lshlrev_b32 v7, 11, v7
    v_lshl_add_u32 v7, v6, 9, v7
    v_lshl_add_u32 v7, v5, 4, v7
    s_sub_u32 s10, s9, 1024
    v_add_u32 v160, s10, v7
    v_add_u32 v5, 48, v0
    v_and_b32 v5, 0x7f, v5
    v_mul_u32_u24 v6, 3121, v5
    v_lshrrev_b32 v6, 16, v6
    v_mul_u32_u24 v7, 21, v6
    v_sub_u32 v5, v5, v7
    v_add_u32 v5, s8, v5
    v_lshrrev_b32 v7, 5, v5
    v_and_b32 v5, 31, v5
    v_lshlrev_b32 v7, 11, v7
    v_lshl_add_u32 v7, v6, 9, v7
    v_lshl_add_u32 v7, v5, 4, v7
    s_sub_u32 s10, s9, 0
    v_add_u32 v161, s10, v7
    v_cmp_gt_u32 vcc, 16, v0
    v_lshrrev_b32 v5, 2, v0
    v_and_b32 v6, 3, v0
    v_cndmask_b32 v160, v160, v2, vcc
    v_mul_u32_u24 v5, 2624, v5
    v_mul_u32_u24 v6, 336, v6
    v_add_u32 v19, v5, v6
    v_mov_b32 v36, 0x3f803f80
    v_mov_b32 v37, 0x3f803f80
    v_mov_b32 v38, 0x3f803f80
    v_mov_b32 v39, 0x3f803f80
    s_lshr_b32 s5, s2, 5
    s_mul_i32 s31, s4, 81920
    s_mul_i32 s10, s5, 10240
    s_add_u32 s31, s31, s10
    s_lshl_b32 s32, s5, 10
    s_add_u32 s32, s32, 0x1300000
    s_lshl_b32 s33, s5, 6
    s_add_u32 s33, s33, 0x1a04000
    s_lshl_b32 s35, s5, 1
    s_lshl_b32 s10, 3, s35
    v_mov_b32 v29, s10
    v_mov_b32 v5, 3
    s_mov_b64 vcc, 0x7fe0
    s_bfe_u32 s10, s2, 0x10004
    s_add_u32 s35, s35, s10
    v_cndmask_b32 v29, v29, v5, vcc
    s_lshl_b32 s35, s35, 6
    s_add_u32 s35, s35, 0x1a06000
    s_add_u32 s9, s8, 19
    s_lshr_b32 s8, s8, 7
    s_lshr_b32 s9, s9, 7
    s_lshl_b32 s8, 0x421, s8
    s_lshl_b32 s9, 0x421, s9
    s_or_b32 s34, s8, s9
    s_or_b32 s34, s34, 0x8000
    s_lshl_b32 s16, s7, 11
    s_mul_i32 s17, s7, 163840
    s_add_u32 s17, s17, s6
    s_add_u32 s31, s31, s65
    s_add_u32 s8, s31, 8192
    s_cmp_lt_u32 s7, 2
    s_cmov_b32 s32, s8
    s_min_u32 s19, s65, 2048
    s_mul_i32 s18, s7, 5248
    s_and_b32 s4, s2, 7
    s_lshl_b32 s4, s4, 3
    s_bfe_u32 s5, s2, 0x30003
    s_add_u32 s4, s4, s5
    s_lshr_b32 s5, s2, 6
    s_mul_i32 s15, s7, 24
    s_mul_i32 s8, s5, 480
    s_add_u32 s8, s8, s15
    s_lshl_b32 s8, s8, 10
    s_add_u32 s8, s8, 0x1400000
    s_add_u32 s9, s8, 98304
    s_add_u32 s10, s9, 98304
    s_add_u32 s11, s10, 98304
    s_add_u32 s12, s11, 98304
    s_mul_i32 s13, s4, 96
    s_add_u32 s13, s13, s15
    s_lshl_b32 s13, s13, 10
    s_add_u32 s13, s13, 0x900000
    s_lshl_b32 s14, s4, 7
    s_add_u32 s14, s14, 0x1300000
    s_lshl_b32 s21, s5, 2
    s_add_u32 s21, s21, s7
    s_mul_i32 s21, s21, 51200
    s_add_u32 s21, s21, 0x1600000
    s_mul_i32 s22, s7, 24576
    s_add_u32 s22, s22, 65536
    s_lshl_b32 s24, s4, 2
    s_add_u32 s24, s24, s7
    s_mul_i32 s25, s24, 10240
    s_add_u32 s25, s25, 0x1000000
    s_mul_i32 s24, s24, 1
    s_and_b32 s15, s5, 0
    s_add_u32 s24, s24, s15
    s_mul_i32 s24, s24, 64
    s_add_u32 s24, s24, 0x1b00000
    s_waitcnt vmcnt(8)
    s_barrier
    s_add_u32 m0, s64, 32768
    s_nop 0
    buffer_load_dwordx4 v10, s[44:47], s66 offen lds
    s_add_u32 m0, s64, 49152
    s_nop 0
    buffer_load_dwordx4 v14, s[48:51], s67 offen lds
    s_add_u32 m0, s64, 33792
    s_nop 0
    buffer_load_dwordx4 v11, s[44:47], s66 offen lds
    s_add_u32 m0, s64, 50176
    s_nop 0
    buffer_load_dwordx4 v15, s[48:51], s67 offen lds
    s_add_u32 m0, s64, 34816
    s_nop 0
    buffer_load_dwordx4 v12, s[44:47], s66 offen lds
    s_add_u32 m0, s64, 51200
    s_nop 0
    buffer_load_dwordx4 v16, s[48:51], s67 offen lds
    s_add_u32 m0, s64, 35840
    s_nop 0
    buffer_load_dwordx4 v13, s[44:47], s66 offen lds
    s_add_u32 m0, s64, 52224
    s_nop 0
    buffer_load_dwordx4 v17, s[48:51], s67 offen lds
    s_add_u32 s66, s66, 128
    s_add_u32 s67, s67, s69
    s_cmp_eq_u32 s66, 1280
    s_cselect_b32 s66, 0, s66
    s_cselect_b32 s67, 0, s67
    s_add_u32 m0, s64, 131072
    s_add_u32 s20, s70, s71
    buffer_load_dwordx4 v22, s[56:59], 0 offen lds
    s_add_u32 m0, s64, 132096
    s_nop 0
    buffer_load_dwordx4 v22, s[56:59], s70 offen lds
    s_add_u32 m0, s64, 133120
    s_nop 0
    buffer_load_dwordx4 v22, s[56:59], s71 offen lds
    s_add_u32 m0, s64, 134144
    s_nop 0
    buffer_load_dwordx4 v22, s[56:59], s20 offen lds
    s_waitcnt vmcnt(12)
    s_barrier
    s_add_u32 m0, s64, 0
    s_nop 0
    buffer_load_dwordx4 v10, s[44:47], s66 offen lds
    s_add_u32 m0, s64, 16384
    s_nop 0
    buffer_load_dwordx4 v14, s[48:51], s67 offen lds
    s_add_u32 m0, s64, 1024
    s_nop 0
    buffer_load_dwordx4 v11, s[44:47], s66 offen lds
    s_add_u32 m0, s64, 17408
    s_nop 0
    buffer_load_dwordx4 v15, s[48:51], s67 offen lds
    s_add_u32 m0, s64, 2048
    s_nop 0
    buffer_load_dwordx4 v12, s[44:47], s66 offen lds
    s_add_u32 m0, s64, 18432
    s_nop 0
    buffer_load_dwordx4 v16, s[48:51], s67 offen lds
    s_add_u32 m0, s64, 3072
    s_nop 0
    buffer_load_dwordx4 v13, s[44:47], s66 offen lds
    s_add_u32 m0, s64, 19456
    s_nop 0
    buffer_load_dwordx4 v17, s[48:51], s67 offen lds
    s_add_u32 s66, s66, 128
    s_add_u32 s67, s67, s69
    s_cmp_eq_u32 s66, 1280
    s_cselect_b32 s66, 0, s66
    s_cselect_b32 s67, 0, s67
    s_waitcnt vmcnt(12)
    s_barrier
    s_add_u32 m0, s64, 98304
    s_nop 0
    buffer_load_dwordx4 v10, s[44:47], s66 offen lds
    s_add_u32 m0, s64, 114688
    s_nop 0
    buffer_load_dwordx4 v14, s[48:51], s67 offen lds
    s_add_u32 m0, s64, 99328
    s_nop 0
    buffer_load_dwordx4 v11, s[44:47], s66 offen lds
    s_add_u32 m0, s64, 115712
    s_nop 0
    buffer_load_dwordx4 v15, s[48:51], s67 offen lds
    s_add_u32 m0, s64, 100352
    s_nop 0
    buffer_load_dwordx4 v12, s[44:47], s66 offen lds
    s_add_u32 m0, s64, 116736
    s_nop 0
    buffer_load_dwordx4 v16, s[48:51], s67 offen lds
    s_add_u32 m0, s64, 101376
    s_nop 0
    buffer_load_dwordx4 v13, s[44:47], s66 offen lds
    s_add_u32 m0, s64, 117760
    s_nop 0
    buffer_load_dwordx4 v17, s[48:51], s67 offen lds
    s_add_u32 s66, s66, 128
    s_add_u32 s67, s67, s69
    s_cmp_eq_u32 s66, 1280
    s_cselect_b32 s66, 0, s66
    s_cselect_b32 s67, 0, s67
    s_waitcnt vmcnt(8)
    ds_read_b64_tr_b16 v[40:41], v23 offset:0
    ds_read_b64_tr_b16 v[42:43], v23 offset:2048
    ds_read_b64_tr_b16 v[44:45], v23 offset:64
    ds_read_b64_tr_b16 v[46:47], v23 offset:2112
    ds_read_b64_tr_b16 v[48:49], v23 offset:128
    ds_read_b64_tr_b16 v[50:51], v23 offset:2176
    ds_read_b64_tr_b16 v[52:53], v23 offset:192
    ds_read_b64_tr_b16 v[54:55], v23 offset:2240
    s_barrier
    s_waitcnt lgkmcnt(6)
    buffer_store_dwordx4 v[40:43], v30, s[36:39], 0 offen sc1
    s_waitcnt lgkmcnt(4)
    buffer_store_dwordx4 v[44:47], v31, s[36:39], 0 offen sc1
    s_waitcnt lgkmcnt(2)
    buffer_store_dwordx4 v[48:51], v32, s[36:39], 0 offen sc1
    s_waitcnt lgkmcnt(0)
    buffer_store_dwordx4 v[52:55], v33, s[36:39], 0 offen sc1
    s_add_u32 m0, s64, 65536
    s_nop 0
    buffer_load_dwordx4 v10, s[44:47], s66 offen lds
    s_add_u32 m0, s64, 81920
    s_nop 0
    buffer_load_dwordx4 v14, s[48:51], s67 offen lds
    s_add_u32 m0, s64, 66560
    s_nop 0
    buffer_load_dwordx4 v11, s[44:47], s66 offen lds
    s_add_u32 m0, s64, 82944
    s_nop 0
    buffer_load_dwordx4 v15, s[48:51], s67 offen lds
    s_add_u32 m0, s64, 67584
    s_nop 0
    buffer_load_dwordx4 v12, s[44:47], s66 offen lds
    s_add_u32 m0, s64, 83968
    s_nop 0
    buffer_load_dwordx4 v16, s[48:51], s67 offen lds
    s_add_u32 m0, s64, 68608
    s_nop 0
    buffer_load_dwordx4 v13, s[44:47], s66 offen lds
    s_add_u32 m0, s64, 84992
    s_nop 0
    buffer_load_dwordx4 v17, s[48:51], s67 offen lds
    s_add_u32 s66, s66, 128
    s_add_u32 s67, s67, s69
    s_cmp_eq_u32 s66, 1280
    s_cselect_b32 s66, 0, s66
    s_cselect_b32 s67, 0, s67
    s_waitcnt vmcnt(12)
    s_barrier
    s_add_u32 m0, s64, 32768
    s_nop 0
    buffer_load_dwordx4 v10, s[44:47], s66 offen lds
    s_add_u32 m0, s64, 49152
    s_nop 0
    buffer_load_dwordx4 v14, s[48:51], s67 offen lds
    s_add_u32 m0, s64, 33792
    s_nop 0
    buffer_load_dwordx4 v11, s[44:47], s66 offen lds
    s_add_u32 m0, s64, 50176
    s_nop 0
    buffer_load_dwordx4 v15, s[48:51], s67 offen lds
    s_add_u32 m0, s64, 34816
    s_nop 0
    buffer_load_dwordx4 v12, s[44:47], s66 offen lds
    s_add_u32 m0, s64, 51200
    s_nop 0
    buffer_load_dwordx4 v16, s[48:51], s67 offen lds
    s_add_u32 m0, s64, 35840
    s_nop 0
    buffer_load_dwordx4 v13, s[44:47], s66 offen lds
    s_add_u32 m0, s64, 52224
    s_nop 0
    buffer_load_dwordx4 v17, s[48:51], s67 offen lds
    s_add_u32 s66, s66, 128
    s_add_u32 s67, s67, s69
    s_cmp_eq_u32 s66, 1280
    s_cselect_b32 s66, 0, s66
    s_cselect_b32 s67, 0, s67
    s_and_b32 s27, s2, 3
    s_lshl_b32 s27, s27, 6
    v_mov_b32 v27, 0
    v_mov_b32 v9, s65
    s_mov_b64 exec, 1
    buffer_atomic_add v27, v9, s[60:63], s27 offen sc0 sc1
    s_mov_b64 exec, -1
    s_waitcnt vmcnt(9)
    s_barrier
    s_add_u32 m0, s64, 0
    s_nop 0
    buffer_load_dwordx4 v10, s[44:47], s66 offen lds
    s_add_u32 m0, s64, 16384
    s_nop 0
    buffer_load_dwordx4 v14, s[48:51], s67 offen lds
    s_add_u32 m0, s64, 1024
    s_nop 0
    buffer_load_dwordx4 v11, s[44:47], s66 offen lds
    s_add_u32 m0, s64, 17408
    s_nop 0
    buffer_load_dwordx4 v15, s[48:51], s67 offen lds
    s_add_u32 m0, s64, 2048
    s_nop 0
    buffer_load_dwordx4 v12, s[44:47], s66 offen lds
    s_add_u32 m0, s64, 18432
    s_nop 0
    buffer_load_dwordx4 v16, s[48:51], s67 offen lds
    s_add_u32 m0, s64, 3072
    s_nop 0
    buffer_load_dwordx4 v13, s[44:47], s66 offen lds
    s_add_u32 m0, s64, 19456
    s_nop 0
    buffer_load_dwordx4 v17, s[48:51], s67 offen lds
    s_add_u32 s66, s66, 128
    s_add_u32 s67, s67, s69
    s_cmp_eq_u32 s66, 1280
    s_cselect_b32 s66, 0, s66
    s_cselect_b32 s67, 0, s67
    s_waitcnt vmcnt(9)
    s_barrier
    s_add_u32 m0, s65, 159744
    s_add_u32 s20, s68, 98304
    buffer_load_dwordx4 v18, s[52:55], s68 offen lds
    s_cmp_eq_u32 s20, 1966080
    s_cselect_b32 s68, 0, s20
    s_add_u32 m0, s65, 155648
    s_add_u32 s20, s68, 98304
    buffer_load_dwordx4 v18, s[52:55], s68 offen lds
    s_cmp_eq_u32 s20, 1966080
    s_cselect_b32 s68, 0, s20
    s_add_u32 m0, s65, 151552
    s_add_u32 s20, s68, 98304
    buffer_load_dwordx4 v18, s[52:55], s68 offen lds
    s_cmp_eq_u32 s20, 1966080
    s_cselect_b32 s68, 0, s20
    s_add_u32 m0, s65, 147456
    s_add_u32 s20, s68, 98304
    buffer_load_dwordx4 v18, s[52:55], s68 offen lds
    s_cmp_eq_u32 s20, 1966080
    s_cselect_b32 s68, 0, s20
    s_add_u32 m0, s65, 143360
    s_add_u32 s20, s68, 98304
    buffer_load_dwordx4 v18, s[52:55], s68 offen lds
    s_cmp_eq_u32 s20, 1966080
    s_cselect_b32 s68, 0, s20
    s_add_u32 m0, s65, 139264
    s_add_u32 s20, s68, 98304
    buffer_load_dwordx4 v18, s[52:55], s68 offen lds
    s_cmp_eq_u32 s20, 1966080
    s_cselect_b32 s68, 0, s20
    s_add_u32 m0, s65, 135168
    s_add_u32 s20, s68, 98304
    buffer_load_dwordx4 v18, s[52:55], s68 offen lds
    s_cmp_eq_u32 s20, 1966080
    s_cselect_b32 s68, 0, s20
    s_add_u32 m0, s65, 131072
    s_add_u32 s20, s68, 98304
    buffer_load_dwordx4 v18, s[52:55], s68 offen lds
    s_cmp_eq_u32 s20, 1966080
    s_cselect_b32 s68, 0, s20
    s_waitcnt vmcnt(8)
    s_barrier
    s_add_u32 m0, s65, 126976
    s_add_u32 s20, s68, 98304
    buffer_load_dwordx4 v18, s[52:55], s68 offen lds
    s_cmp_eq_u32 s20, 1966080
    s_cselect_b32 s68, 0, s20
    s_add_u32 m0, s65, 122880
    s_add_u32 s20, s68, 98304
    buffer_load_dwordx4 v18, s[52:55], s68 offen lds
    s_cmp_eq_u32 s20, 1966080
    s_cselect_b32 s68, 0, s20
    s_add_u32 m0, s65, 118784
    s_add_u32 s20, s68, 98304
    buffer_load_dwordx4 v18, s[52:55], s68 offen lds
    s_cmp_eq_u32 s20, 1966080
    s_cselect_b32 s68, 0, s20
    s_add_u32 m0, s65, 114688
    s_add_u32 s20, s68, 98304
    buffer_load_dwordx4 v18, s[52:55], s68 offen lds
    s_cmp_eq_u32 s20, 1966080
    s_cselect_b32 s68, 0, s20
    s_add_u32 m0, s65, 110592
    s_add_u32 s20, s68, 98304
    buffer_load_dwordx4 v18, s[52:55], s68 offen lds
    s_cmp_eq_u32 s20, 1966080
    s_cselect_b32 s68, 0, s20
    s_add_u32 m0, s65, 106496
    s_add_u32 s20, s68, 98304
    buffer_load_dwordx4 v18, s[52:55], s68 offen lds
    s_cmp_eq_u32 s20, 1966080
    s_cselect_b32 s68, 0, s20
    s_add_u32 m0, s65, 102400
    s_add_u32 s20, s68, 98304
    buffer_load_dwordx4 v18, s[52:55], s68 offen lds
    s_cmp_eq_u32 s20, 1966080
    s_cselect_b32 s68, 0, s20
    s_add_u32 m0, s65, 98304
    s_add_u32 s20, s68, 98304
    buffer_load_dwordx4 v18, s[52:55], s68 offen lds
    s_cmp_eq_u32 s20, 1966080
    s_cselect_b32 s68, 0, s20
    s_waitcnt vmcnt(12)
    v_readfirstlane_b32 s15, v27
    s_or_b32 s15, s15, s7
    s_cmp_lg_u32 s15, 0
    s_cbranch_scc1 KF_ZOK
    s_mov_b64 exec, 1
    s_mov_b32 s26, 0
KF_ZPOLL:
    v_mov_b32 v8, 0
    buffer_atomic_add v8, v9, s[60:63], s27 offen sc0 sc1
KF_ZPOLL_W:
    s_add_u32 s26, s26, 1
    s_waitcnt vmcnt(0)
    v_cmp_gt_u32 vcc, 1, v8
    s_cmp_gt_u32 s26, 400000
    s_cbranch_scc1 KF_ZPOLL_DONE
    s_cbranch_vccnz KF_ZPOLL
KF_ZPOLL_DONE:
    s_mov_b64 exec, -1
KF_ZOK:
    s_barrier
    s_add_u32 m0, s65, 94208
    s_add_u32 s20, s68, 98304
    buffer_load_dwordx4 v18, s[52:55], s68 offen lds
    s_cmp_eq_u32 s20, 1966080
    s_cselect_b32 s68, 0, s20
    s_add_u32 m0, s65, 90112
    s_add_u32 s20, s68, 98304
    buffer_load_dwordx4 v18, s[52:55], s68 offen lds
    s_cmp_eq_u32 s20, 1966080
    s_cselect_b32 s68, 0, s20
    s_add_u32 m0, s65, 86016
    s_add_u32 s20, s68, 98304
    buffer_load_dwordx4 v18, s[52:55], s68 offen lds
    s_cmp_eq_u32 s20, 1966080
    s_cselect_b32 s68, 0, s20
    s_add_u32 m0, s65, 81920
    s_add_u32 s20, s68, 98304
    buffer_load_dwordx4 v18, s[52:55], s68 offen lds
    s_cmp_eq_u32 s20, 1966080
    s_cselect_b32 s68, 0, s20
    v_mul_u32_u24 v9, 512, v0
    v_add_u32 v8, s65, v2
    v_mov_b32 v40, 0
    v_mov_b32 v41, 0
    v_mov_b32 v42, 0
    v_mov_b32 v43, 0
    ds_write_b128 v8, v[40:43] offset:61440
    s_waitcnt lgkmcnt(0)
    s_waitcnt vmcnt(10)
    s_barrier
    s_add_u32 m0, s65, 77824
    s_add_u32 s20, s68, 196608
    buffer_load_dwordx4 v20, s[52:55], s68 offen lds
    s_cmp_eq_u32 s20, 1966080
    s_cselect_b32 s68, 0, s20
    s_add_u32 m0, s65, 73728
    s_add_u32 s20, s68, 196608
    buffer_load_dwordx4 v20, s[52:55], s68 offen lds
    s_cmp_eq_u32 s20, 1966080
    s_cselect_b32 s68, 0, s20
    s_add_u32 m0, s65, 69632
    s_add_u32 s20, s68, 196608
    buffer_load_dwordx4 v20, s[52:55], s68 offen lds
    s_cmp_eq_u32 s20, 1966080
    s_cselect_b32 s68, 0, s20
    s_mov_b32 exec_hi, 0
    ds_write_b128 v19, v[36:39] offset:1600
    s_mov_b64 exec, -1
    v_mov_b32 v27, 1
    s_cmp_eq_u32 s7, 0
    s_cselect_b32 s20, 0, 0x40000000
    v_add_u32 v24, s20, v9
    s_waitcnt vmcnt(6)
    s_barrier
    s_add_u32 m0, s65, 65536
    s_add_u32 s20, s68, 196608
    buffer_load_dwordx4 v20, s[52:55], s68 offen lds
    s_cmp_eq_u32 s20, 1966080
    s_cselect_b32 s68, 0, s20
    s_add_u32 m0, s65, 57344
    s_add_u32 s20, s68, 196608
    buffer_load_dwordx4 v20, s[52:55], s68 offen lds
    s_cmp_eq_u32 s20, 1966080
    s_cselect_b32 s68, 0, s20
    s_add_u32 m0, s65, 53248
    s_add_u32 s20, s68, 196608
    buffer_load_dwordx4 v20, s[52:55], s68 offen lds
    s_cmp_eq_u32 s20, 1966080
    s_cselect_b32 s68, 0, s20
    s_add_u32 m0, s65, 49152
    s_add_u32 s20, s68, 196608
    buffer_load_dwordx4 v20, s[52:55], s68 offen lds
    s_cmp_eq_u32 s20, 1966080
    s_cselect_b32 s68, 0, s20
    s_waitcnt vmcnt(7)
    s_barrier
    s_add_u32 m0, s65, 45056
    s_add_u32 s20, s68, 196608
    buffer_load_dwordx4 v20, s[52:55], s68 offen lds
    s_cmp_eq_u32 s20, 1966080
    s_cselect_b32 s68, 0, s20
    s_add_u32 m0, s65, 40960
    s_add_u32 s20, s68, 196608
    buffer_load_dwordx4 v20, s[52:55], s68 offen lds
    s_cmp_eq_u32 s20, 1966080
    s_cselect_b32 s68, 0, s20
    s_add_u32 m0, s65, 36864
    s_add_u32 s20, s68, 196608
    buffer_load_dwordx4 v20, s[52:55], s68 offen lds
    s_cmp_eq_u32 s20, 1966080
    s_cselect_b32 s68, 0, s20
    s_waitcnt vmcnt(5)
    s_barrier
    s_mov_b32 exec_lo, s34
    s_mov_b32 exec_hi, 0
    v_mov_b32 v8, 0
    buffer_atomic_add v8, v24, s[36:39], s33 offen sc0 sc1
    s_mov_b64 exec, -1
    s_waitcnt vmcnt(1)
    s_barrier
    s_cmp_lg_u32 s7, 0
    s_cbranch_scc1 KF_GOW
    s_mov_b32 exec_lo, s34
    s_mov_b32 exec_hi, 0
    s_mov_b32 s26, 0
    s_branch KF_POLL1_W
KF_POLL1:
    v_mov_b32 v8, 0
    buffer_atomic_add v8, v9, s[36:39], s33 offen sc0 sc1
KF_POLL1_W:
    s_add_u32 s26, s26, 1
    s_waitcnt vmcnt(0)
    v_and_b32 v8, v29, v8
    v_cmp_ne_u32 vcc, v29, v8
    s_cmp_gt_u32 s26, 400000
    s_cbranch_scc1 KF_POLL1_DONE
    s_cbranch_vccnz KF_POLL1
KF_POLL1_DONE:
    ds_write_b32 v40, v27 offset:63040
    s_mov_b64 exec, -1
    s_branch KF_GOW_DONE
KF_GOW:
    s_mov_b32 s26, 0
KF_GOWL:
    s_sleep 1
    ds_read_b32 v8, v40 offset:63040
    s_add_u32 s26, s26, 1
    s_waitcnt lgkmcnt(0)
    v_cmp_eq_u32 vcc, 0, v8
    s_cmp_gt_u32 s26, 400000
    s_cbranch_scc1 KF_GOWL_DONE
    s_cbranch_vccnz KF_GOWL
KF_GOWL_DONE:
KF_GOW_DONE:
    s_add_u32 m0, s65, 20992
    s_add_u32 s20, s31, 4096
    buffer_load_dwordx4 v2, s[36:39], s31 offen lds
    s_add_u32 m0, s65, 25088
    s_and_b32 s34, s34, 0x7fe0
    buffer_load_dwordx4 v2, s[36:39], s20 offen lds
    s_add_u32 m0, s19, 29184
    s_nop 0
    buffer_load_dwordx4 v2, s[36:39], s32 offen lds
    s_add_u32 m0, s18, 0
    s_add_u32 s20, s17, 79296
    buffer_load_dwordx4 v2, s[36:39], s17 offen lds
    buffer_load_dwordx4 v2, s[36:39], s20 offen offset:2624 lds
    s_mov_b32 exec_hi, 0xfdffffef
    buffer_load_dwordx4 v160, s[36:39], s17 offen offset:1024 lds
    buffer_load_dwordx4 v160, s[36:39], s20 offen offset:3648 lds
    s_add_u32 m0, s18, 2048
    s_mov_b32 exec_lo, 0xffffbfff
    s_mov_b32 exec_hi, 7
    buffer_load_dwordx4 v161, s[36:39], s17 offen lds
    buffer_load_dwordx4 v161, s[36:39], s20 offen offset:2624 lds
    s_mov_b64 exec, -1
    s_add_u32 s17, s17, 655360
    s_cmp_lg_u32 s7, 0
    s_cbranch_scc1 KF_P4
    s_mov_b32 exec_lo, s34
    s_mov_b32 exec_hi, 0
    v_mov_b32 v8, 0
    buffer_atomic_add v8, v9, s[36:39], s33 offen sc0 sc1
    s_waitcnt vmcnt(0)
    v_and_b32 v8, 0x3f, v8
    v_cmp_ne_u32 vcc, 0x3f, v8
    s_cbranch_vccnz KF_P4
    ds_write_b32 v40, v27 offset:63044
KF_P4:
    s_mov_b64 exec, -1
    s_waitcnt vmcnt(0) lgkmcnt(0)
    s_barrier
    ds_read_b32 v8, v40 offset:63044
    s_mov_b32 exec_hi, 0
    ds_write_b128 v19, v[36:39] offset:43584
    s_waitcnt lgkmcnt(0)
    v_cmp_ne_u32 vcc, 0, v8
    s_mov_b32 exec_lo, s34
    s_cbranch_vccnz KF_POLL4_DONE
    s_mov_b32 s26, 0
KF_POLL4:
    v_mov_b32 v8, 0
    buffer_atomic_add v8, v9, s[36:39], s33 offen sc0 sc1
KF_POLL4_W:
    s_add_u32 s26, s26, 1
    s_waitcnt vmcnt(0)
    v_and_b32 v8, 0x3f, v8
    v_cmp_ne_u32 vcc, 0x3f, v8
    s_cmp_gt_u32 s26, 400000
    s_cbranch_scc1 KF_POLL4_DONE
    s_cbranch_vccnz KF_POLL4
KF_POLL4_DONE:
    s_mov_b64 exec, -1
    s_add_u32 m0, s18, 41984
    s_add_u32 s20, s17, 79296
    buffer_load_dwordx4 v2, s[36:39], s17 offen lds
    buffer_load_dwordx4 v2, s[36:39], s20 offen offset:2624 lds
    s_mov_b32 exec_hi, 0xfdffffef
    buffer_load_dwordx4 v160, s[36:39], s17 offen offset:1024 lds
    buffer_load_dwordx4 v160, s[36:39], s20 offen offset:3648 lds
    s_add_u32 m0, s18, 44032
    s_mov_b32 exec_lo, 0xffffbfff
    s_mov_b32 exec_hi, 7
    buffer_load_dwordx4 v161, s[36:39], s17 offen lds
    buffer_load_dwordx4 v161, s[36:39], s20 offen offset:2624 lds
    s_mov_b64 exec, -1
    s_add_u32 s17, s17, 655360
    v_lshlrev_b32 v5, 2, v3
    v_mul_u32_u24 v7, 2560, v4
    v_lshl_add_u32 v7, v3, 3, v7
    v_mul_u32_u24 v3, 144, v3
    v_lshl_add_u32 v3, v4, 4, v3
    v_add_u32 v3, s22, v3
    v_mul_u32_u24 v9, 1024, v0
    s_waitcnt vmcnt(0)
    s_barrier
    s_add_u32 m0, s18, 20992
    s_add_u32 s20, s17, 79296
    buffer_load_dwordx4 v2, s[36:39], s17 offen lds
    buffer_load_dwordx4 v2, s[36:39], s20 offen offset:2624 lds
    s_mov_b32 exec_hi, 0xfdffffef
    buffer_load_dwordx4 v160, s[36:39], s17 offen offset:1024 lds
    buffer_load_dwordx4 v160, s[36:39], s20 offen offset:3648 lds
    s_add_u32 m0, s18, 23040
    s_mov_b32 exec_lo, 0xffffbfff
    s_mov_b32 exec_hi, 7
    buffer_load_dwordx4 v161, s[36:39], s17 offen lds
    buffer_load_dwordx4 v161, s[36:39], s20 offen offset:2624 lds
    s_mov_b64 exec, -1
    s_add_u32 s17, s17, 655360
    s_mov_b32 exec_hi, 0
    ds_write_b128 v19, v[36:39] offset:22592
    s_mov_b64 exec, -1
    s_waitcnt vmcnt(0)
    s_cmp_lg_u32 s7, 0
    s_cbranch_scc1 KF_G2A_X
    s_mov_b64 exec, 0xffff
    s_mov_b32 s26, 1
KF_G2A:
    v_mov_b32 v8, 0
    buffer_atomic_add v8, v9, s[36:39], s35 offen sc0 sc1
    s_cmp_eq_u32 s26, 3
    s_cbranch_scc1 KF_G2A_X
    s_add_u32 s26, s26, 1
    s_waitcnt vmcnt(0)
    v_cmp_gt_u32 vcc, 16, v8
    s_cbranch_vccnz KF_G2A
    ds_write_b32 v40, v27 offset:63048
KF_G2A_X:
    s_mov_b64 exec, -1
    s_waitcnt lgkmcnt(0)
    s_barrier
    s_cmp_lg_u32 s7, 0
    s_cbranch_scc1 KF_G2W
    s_mov_b64 exec, 0xffff
    s_mov_b32 s26, 0
    s_branch KF_POLL2_W
KF_POLL2:
    v_mov_b32 v8, 0
    buffer_atomic_add v8, v9, s[36:39], s35 offen sc0 sc1
KF_POLL2_W:
    s_add_u32 s26, s26, 1
    s_waitcnt vmcnt(0)
    v_cmp_gt_u32 vcc, 16, v8
    s_cmp_gt_u32 s26, 400000
    s_cbranch_scc1 KF_POLL2_DONE
    s_cbranch_vccnz KF_POLL2
KF_POLL2_DONE:
    ds_write_b32 v40, v27 offset:63048
    s_mov_b64 exec, -1
    s_branch KF_G2W_DONE
KF_G2W:
    s_mov_b32 s26, 0
KF_G2L:
    s_sleep 1
    ds_read_b32 v8, v40 offset:63048
    s_add_u32 s26, s26, 1
    s_waitcnt lgkmcnt(0)
    v_cmp_eq_u32 vcc, 0, v8
    s_cmp_gt_u32 s26, 400000
    s_cbranch_scc1 KF_G2L_DONE
    s_cbranch_vccnz KF_G2L
KF_G2L_DONE:
    s_waitcnt vmcnt(0)
KF_G2W_DONE:
    s_add_u32 m0, s18, 0
    s_add_u32 s20, s17, 79296
    buffer_load_dwordx4 v2, s[36:39], s17 offen lds
    buffer_load_dwordx4 v2, s[36:39], s20 offen offset:2624 lds
    s_mov_b32 exec_hi, 0xfdffffef
    buffer_load_dwordx4 v160, s[36:39], s17 offen offset:1024 lds
    buffer_load_dwordx4 v160, s[36:39], s20 offen offset:3648 lds
    s_add_u32 m0, s18, 2048
    s_mov_b32 exec_lo, 0xffffbfff
    s_mov_b32 exec_hi, 7
    buffer_load_dwordx4 v161, s[36:39], s17 offen lds
    buffer_load_dwordx4 v161, s[36:39], s20 offen offset:2624 lds
    s_mov_b64 exec, -1
    s_add_u32 s17, s17, 655360
    buffer_load_dwordx4 v[88:91], v2, s[36:39], s8 offen offset:0
    buffer_load_dwordx4 v[92:95], v2, s[36:39], s9 offen offset:0
    buffer_load_dwordx4 v[96:99], v2, s[36:39], s10 offen offset:0
    buffer_load_dwordx4 v[100:103], v2, s[36:39], s11 offen offset:0
    buffer_load_dwordx4 v[104:107], v2, s[36:39], s12 offen offset:0
    buffer_load_dwordx4 v[108:111], v2, s[36:39], s13 offen offset:0
    buffer_load_dwordx4 v[112:115], v2, s[36:39], s8 offen offset:1024
    buffer_load_dwordx4 v[116:119], v2, s[36:39], s9 offen offset:1024
    buffer_load_dwordx4 v[120:123], v2, s[36:39], s10 offen offset:1024
    buffer_load_dwordx4 v[124:127], v2, s[36:39], s11 offen offset:1024
    buffer_load_dwordx4 v[128:131], v2, s[36:39], s12 offen offset:1024
    buffer_load_dwordx4 v[132:135], v2, s[36:39], s13 offen offset:1024
    buffer_load_dwordx4 v[136:139], v2, s[36:39], s8 offen offset:2048
    buffer_load_dwordx4 v[140:143], v2, s[36:39], s9 offen offset:2048
    buffer_load_dwordx4 v[144:147], v2, s[36:39], s10 offen offset:2048
    buffer_load_dwordx4 v[148:151], v2, s[36:39], s11 offen offset:2048
    buffer_load_dwordx4 v[152:155], v2, s[36:39], s12 offen offset:2048
    buffer_load_dwordx4 v[156:159], v2, s[36:39], s13 offen offset:2048
    buffer_load_dword v6, v5, s[36:39], s14 offen
    s_add_u32 m0, s22, 0
    s_add_u32 s20, s21, 0
    buffer_load_dwordx4 v2, s[36:39], s20 offen lds
    s_add_u32 m0, s22, 12288
    s_add_u32 s20, s21, 20480
    buffer_load_dwordx4 v2, s[36:39], s20 offen lds
    s_add_u32 m0, s22, 1024
    s_add_u32 s20, s21, 5120
    buffer_load_dwordx4 v2, s[36:39], s20 offen lds
    s_add_u32 m0, s22, 13312
    s_add_u32 s20, s21, 25600
    buffer_load_dwordx4 v2, s[36:39], s20 offen lds
    s_waitcnt vmcnt(17)
    v_mfma_f32_32x32x16_bf16 v[8:23], v[88:91], v[108:111], 0
    v_mfma_f32_32x32x16_bf16 v[24:39], v[92:95], v[108:111], 0
    buffer_load_dwordx4 v[88:91], v2, s[36:39], s8 offen offset:3072
    s_add_u32 s8, s8, 4096
    v_mfma_f32_32x32x16_bf16 v[40:55], v[96:99], v[108:111], 0
    buffer_load_dwordx4 v[92:95], v2, s[36:39], s9 offen offset:3072
    s_add_u32 s9, s9, 4096
    v_mfma_f32_32x32x16_bf16 v[56:71], v[100:103], v[108:111], 0
    buffer_load_dwordx4 v[96:99], v2, s[36:39], s10 offen offset:3072
    s_add_u32 s10, s10, 4096
    v_mfma_f32_32x32x16_bf16 v[72:87], v[104:107], v[108:111], 0
    buffer_load_dwordx4 v[100:103], v2, s[36:39], s11 offen offset:3072
    s_add_u32 s11, s11, 4096
    buffer_load_dwordx4 v[104:107], v2, s[36:39], s12 offen offset:3072
    s_add_u32 s12, s12, 4096
    buffer_load_dwordx4 v[108:111], v2, s[36:39], s13 offen offset:3072
    s_add_u32 s13, s13, 4096
    s_waitcnt vmcnt(17)
    v_mfma_f32_32x32x16_bf16 v[8:23], v[112:115], v[132:135], v[8:23]
    v_mfma_f32_32x32x16_bf16 v[24:39], v[116:119], v[132:135], v[24:39]
    buffer_load_dwordx4 v[112:115], v2, s[36:39], s8 offen offset:0
    v_mfma_f32_32x32x16_bf16 v[40:55], v[120:123], v[132:135], v[40:55]
    buffer_load_dwordx4 v[116:119], v2, s[36:39], s9 offen offset:0
    v_mfma_f32_32x32x16_bf16 v[56:71], v[124:127], v[132:135], v[56:71]
    buffer_load_dwordx4 v[120:123], v2, s[36:39], s10 offen offset:0
    v_mfma_f32_32x32x16_bf16 v[72:87], v[128:131], v[132:135], v[72:87]
    buffer_load_dwordx4 v[124:127], v2, s[36:39], s11 offen offset:0
    buffer_load_dwordx4 v[128:131], v2, s[36:39], s12 offen offset:0
    buffer_load_dwordx4 v[132:135], v2, s[36:39], s13 offen offset:0
    s_barrier
    s_add_u32 m0, s18, 41984
    s_add_u32 s20, s17, 79296
    buffer_load_dwordx4 v2, s[36:39], s17 offen lds
    buffer_load_dwordx4 v2, s[36:39], s20 offen offset:2624 lds
    s_mov_b32 exec_hi, 0xfdffffef
    buffer_load_dwordx4 v160, s[36:39], s17 offen offset:1024 lds
    buffer_load_dwordx4 v160, s[36:39], s20 offen offset:3648 lds
    s_add_u32 m0, s18, 44032
    s_mov_b32 exec_lo, 0xffffbfff
    s_mov_b32 exec_hi, 7
    buffer_load_dwordx4 v161, s[36:39], s17 offen lds
    buffer_load_dwordx4 v161, s[36:39], s20 offen offset:2624 lds
    s_mov_b64 exec, -1
    s_add_u32 s17, s17, 655360
    s_add_u32 m0, s22, 2048
    s_add_u32 s20, s21, 10240
    buffer_load_dwordx4 v2, s[36:39], s20 offen lds
    s_add_u32 m0, s22, 14336
    s_add_u32 s20, s21, 30720
    buffer_load_dwordx4 v2, s[36:39], s20 offen lds
    s_add_u32 m0, s22, 3072
    s_add_u32 s20, s21, 15360
    buffer_load_dwordx4 v2, s[36:39], s20 offen lds
    s_add_u32 m0, s22, 15360
    s_add_u32 s20, s21, 35840
    buffer_load_dwordx4 v2, s[36:39], s20 offen lds
    s_waitcnt vmcnt(27)
    v_mfma_f32_32x32x16_bf16 v[8:23], v[136:139], v[156:159], v[8:23]
    v_mfma_f32_32x32x16_bf16 v[24:39], v[140:143], v[156:159], v[24:39]
    buffer_load_dwordx4 v[136:139], v2, s[36:39], s8 offen offset:1024
    v_mfma_f32_32x32x16_bf16 v[40:55], v[144:147], v[156:159], v[40:55]
    buffer_load_dwordx4 v[140:143], v2, s[36:39], s9 offen offset:1024
    v_mfma_f32_32x32x16_bf16 v[56:71], v[148:151], v[156:159], v[56:71]
    buffer_load_dwordx4 v[144:147], v2, s[36:39], s10 offen offset:1024
    v_mfma_f32_32x32x16_bf16 v[72:87], v[152:155], v[156:159], v[72:87]
    buffer_load_dwordx4 v[148:151], v2, s[36:39], s11 offen offset:1024
    buffer_load_dwordx4 v[152:155], v2, s[36:39], s12 offen offset:1024
    buffer_load_dwordx4 v[156:159], v2, s[36:39], s13 offen offset:1024
    s_waitcnt vmcnt(22)
    v_mfma_f32_32x32x16_bf16 v[8:23], v[88:91], v[108:111], v[8:23]
    v_mfma_f32_32x32x16_bf16 v[24:39], v[92:95], v[108:111], v[24:39]
    buffer_load_dwordx4 v[88:91], v2, s[36:39], s8 offen offset:2048
    v_mfma_f32_32x32x16_bf16 v[40:55], v[96:99], v[108:111], v[40:55]
    buffer_load_dwordx4 v[92:95], v2, s[36:39], s9 offen offset:2048
    v_mfma_f32_32x32x16_bf16 v[56:71], v[100:103], v[108:111], v[56:71]
    buffer_load_dwordx4 v[96:99], v2, s[36:39], s10 offen offset:2048
    v_mfma_f32_32x32x16_bf16 v[72:87], v[104:107], v[108:111], v[72:87]
    buffer_load_dwordx4 v[100:103], v2, s[36:39], s11 offen offset:2048
    buffer_load_dwordx4 v[104:107], v2, s[36:39], s12 offen offset:2048
    buffer_load_dwordx4 v[108:111], v2, s[36:39], s13 offen offset:2048
    s_waitcnt vmcnt(22)
    v_mfma_f32_32x32x16_bf16 v[8:23], v[112:115], v[132:135], v[8:23]
    v_mfma_f32_32x32x16_bf16 v[24:39], v[116:119], v[132:135], v[24:39]
    buffer_load_dwordx4 v[112:115], v2, s[36:39], s8 offen offset:3072
    s_add_u32 s8, s8, 4096
    v_mfma_f32_32x32x16_bf16 v[40:55], v[120:123], v[132:135], v[40:55]
    buffer_load_dwordx4 v[116:119], v2, s[36:39], s9 offen offset:3072
    s_add_u32 s9, s9, 4096
    v_mfma_f32_32x32x16_bf16 v[56:71], v[124:127], v[132:135], v[56:71]
    buffer_load_dwordx4 v[120:123], v2, s[36:39], s10 offen offset:3072
    s_add_u32 s10, s10, 4096
    v_mfma_f32_32x32x16_bf16 v[72:87], v[128:131], v[132:135], v[72:87]
    buffer_load_dwordx4 v[124:127], v2, s[36:39], s11 offen offset:3072
    s_add_u32 s11, s11, 4096
    buffer_load_dwordx4 v[128:131], v2, s[36:39], s12 offen offset:3072
    s_add_u32 s12, s12, 4096
    buffer_load_dwordx4 v[132:135], v2, s[36:39], s13 offen offset:3072
    s_add_u32 s13, s13, 4096
    s_waitcnt vmcnt(12)
    v_mfma_f32_32x32x16_bf16 v[8:23], v[136:139], v[156:159], v[8:23]
    v_mfma_f32_32x32x16_bf16 v[24:39], v[140:143], v[156:159], v[24:39]
    buffer_load_dwordx4 v[136:139], v2, s[36:39], s8 offen offset:0
    v_mfma_f32_32x32x16_bf16 v[40:55], v[144:147], v[156:159], v[40:55]
    buffer_load_dwordx4 v[140:143], v2, s[36:39], s9 offen offset:0
    v_mfma_f32_32x32x16_bf16 v[56:71], v[148:151], v[156:159], v[56:71]
    buffer_load_dwordx4 v[144:147], v2, s[36:39], s10 offen offset:0
    v_mfma_f32_32x32x16_bf16 v[72:87], v[152:155], v[156:159], v[72:87]
    buffer_load_dwordx4 v[148:151], v2, s[36:39], s11 offen offset:0
    buffer_load_dwordx4 v[152:155], v2, s[36:39], s12 offen offset:0
    buffer_load_dwordx4 v[156:159], v2, s[36:39], s13 offen offset:0
    s_waitcnt vmcnt(12)
    v_mfma_f32_32x32x16_bf16 v[8:23], v[88:91], v[108:111], v[8:23]
    v_mfma_f32_32x32x16_bf16 v[24:39], v[92:95], v[108:111], v[24:39]
    buffer_load_dwordx4 v[88:91], v2, s[36:39], s8 offen offset:1024
    v_mfma_f32_32x32x16_bf16 v[40:55], v[96:99], v[108:111], v[40:55]
    buffer_load_dwordx4 v[92:95], v2, s[36:39], s9 offen offset:1024
    v_mfma_f32_32x32x16_bf16 v[56:71], v[100:103], v[108:111], v[56:71]
    buffer_load_dwordx4 v[96:99], v2, s[36:39], s10 offen offset:1024
    v_mfma_f32_32x32x16_bf16 v[72:87], v[104:107], v[108:111], v[72:87]
    buffer_load_dwordx4 v[100:103], v2, s[36:39], s11 offen offset:1024
    buffer_load_dwordx4 v[104:107], v2, s[36:39], s12 offen offset:1024
    buffer_load_dwordx4 v[108:111], v2, s[36:39], s13 offen offset:1024
    s_barrier
    s_add_u32 m0, s18, 20992
    s_add_u32 s20, s17, 79296
    buffer_load_dwordx4 v2, s[36:39], s17 offen lds
    buffer_load_dwordx4 v2, s[36:39], s20 offen offset:2624 lds
    s_mov_b32 exec_hi, 0xfdffffef
    buffer_load_dwordx4 v160, s[36:39], s17 offen offset:1024 lds
    buffer_load_dwordx4 v160, s[36:39], s20 offen offset:3648 lds
    s_add_u32 m0, s18, 23040
    s_mov_b32 exec_lo, 0xffffbfff
    s_mov_b32 exec_hi, 7
    buffer_load_dwordx4 v161, s[36:39], s17 offen lds
    buffer_load_dwordx4 v161, s[36:39], s20 offen offset:2624 lds
    s_mov_b64 exec, -1
    s_add_u32 s17, s17, 655360
    v_sub_f32 v4, 1.0, v6
    v_sub_f32 v5, 1.0, v6
    v_mov_b32 v1, 0
    ds_write_b32 v2, v1 offset:64512
    s_mov_b32 s15, 0
    s_add_u32 m0, s22, 4096
    s_add_u32 s20, s21, 1024
    buffer_load_dwordx4 v2, s[36:39], s20 offen lds
    s_add_u32 m0, s22, 16384
    s_add_u32 s20, s21, 21504
    buffer_load_dwordx4 v2, s[36:39], s20 offen lds
    s_add_u32 m0, s22, 5120
    s_add_u32 s20, s21, 6144
    buffer_load_dwordx4 v2, s[36:39], s20 offen lds
    s_add_u32 m0, s22, 17408
    s_add_u32 s20, s21, 26624
    buffer_load_dwordx4 v2, s[36:39], s20 offen lds
    s_waitcnt vmcnt(22)
    v_mfma_f32_32x32x16_bf16 v[8:23], v[112:115], v[132:135], v[8:23]
    v_mfma_f32_32x32x16_bf16 v[24:39], v[116:119], v[132:135], v[24:39]
    buffer_load_dwordx4 v[112:115], v2, s[36:39], s8 offen offset:2048
    v_mfma_f32_32x32x16_bf16 v[40:55], v[120:123], v[132:135], v[40:55]
    buffer_load_dwordx4 v[116:119], v2, s[36:39], s9 offen offset:2048
    v_mfma_f32_32x32x16_bf16 v[56:71], v[124:127], v[132:135], v[56:71]
    buffer_load_dwordx4 v[120:123], v2, s[36:39], s10 offen offset:2048
    v_mfma_f32_32x32x16_bf16 v[72:87], v[128:131], v[132:135], v[72:87]
    buffer_load_dwordx4 v[124:127], v2, s[36:39], s11 offen offset:2048
    buffer_load_dwordx4 v[128:131], v2, s[36:39], s12 offen offset:2048
    buffer_load_dwordx4 v[132:135], v2, s[36:39], s13 offen offset:2048
    s_waitcnt vmcnt(22)
    v_mfma_f32_32x32x16_bf16 v[8:23], v[136:139], v[156:159], v[8:23]
    v_mfma_f32_32x32x16_bf16 v[24:39], v[140:143], v[156:159], v[24:39]
    buffer_load_dwordx4 v[136:139], v2, s[36:39], s8 offen offset:3072
    s_add_u32 s8, s8, 4096
    v_mfma_f32_32x32x16_bf16 v[40:55], v[144:147], v[156:159], v[40:55]
    buffer_load_dwordx4 v[140:143], v2, s[36:39], s9 offen offset:3072
    s_add_u32 s9, s9, 4096
    v_mfma_f32_32x32x16_bf16 v[56:71], v[148:151], v[156:159], v[56:71]
    buffer_load_dwordx4 v[144:147], v2, s[36:39], s10 offen offset:3072
    s_add_u32 s10, s10, 4096
    v_mfma_f32_32x32x16_bf16 v[72:87], v[152:155], v[156:159], v[72:87]
    buffer_load_dwordx4 v[148:151], v2, s[36:39], s11 offen offset:3072
    s_add_u32 s11, s11, 4096
    buffer_load_dwordx4 v[152:155], v2, s[36:39], s12 offen offset:3072
    s_add_u32 s12, s12, 4096
    buffer_load_dwordx4 v[156:159], v2, s[36:39], s13 offen offset:3072
    s_add_u32 s13, s13, 4096
    s_waitcnt vmcnt(22)
    v_mfma_f32_32x32x16_bf16 v[8:23], v[88:91], v[108:111], v[8:23]
    v_mfma_f32_32x32x16_bf16 v[24:39], v[92:95], v[108:111], v[24:39]
    buffer_load_dwordx4 v[88:91], v2, s[36:39], s8 offen offset:0
    v_mfma_f32_32x32x16_bf16 v[40:55], v[96:99], v[108:111], v[40:55]
    buffer_load_dwordx4 v[92:95], v2, s[36:39], s9 offen offset:0
    v_mfma_f32_32x32x16_bf16 v[56:71], v[100:103], v[108:111], v[56:71]
    buffer_load_dwordx4 v[96:99], v2, s[36:39], s10 offen offset:0
    v_mfma_f32_32x32x16_bf16 v[72:87], v[104:107], v[108:111], v[72:87]
    buffer_load_dwordx4 v[100:103], v2, s[36:39], s11 offen offset:0
    buffer_load_dwordx4 v[104:107], v2, s[36:39], s12 offen offset:0
    buffer_load_dwordx4 v[108:111], v2, s[36:39], s13 offen offset:0
    s_waitcnt vmcnt(12)
    v_mfma_f32_32x32x16_bf16 v[8:23], v[112:115], v[132:135], v[8:23]
    v_mfma_f32_32x32x16_bf16 v[24:39], v[116:119], v[132:135], v[24:39]
    buffer_load_dwordx4 v[112:115], v2, s[36:39], s8 offen offset:1024
    v_mfma_f32_32x32x16_bf16 v[40:55], v[120:123], v[132:135], v[40:55]
    buffer_load_dwordx4 v[116:119], v2, s[36:39], s9 offen offset:1024
    v_mfma_f32_32x32x16_bf16 v[56:71], v[124:127], v[132:135], v[56:71]
    buffer_load_dwordx4 v[120:123], v2, s[36:39], s10 offen offset:1024
    v_mfma_f32_32x32x16_bf16 v[72:87], v[128:131], v[132:135], v[72:87]
    buffer_load_dwordx4 v[124:127], v2, s[36:39], s11 offen offset:1024
    buffer_load_dwordx4 v[128:131], v2, s[36:39], s12 offen offset:1024
    buffer_load_dwordx4 v[132:135], v2, s[36:39], s13 offen offset:1024
    s_waitcnt vmcnt(12)
    v_mfma_f32_32x32x16_bf16 v[8:23], v[136:139], v[156:159], v[8:23]
    v_mfma_f32_32x32x16_bf16 v[24:39], v[140:143], v[156:159], v[24:39]
    buffer_load_dwordx4 v[136:139], v2, s[36:39], s8 offen offset:2048
    v_mfma_f32_32x32x16_bf16 v[40:55], v[144:147], v[156:159], v[40:55]
    buffer_load_dwordx4 v[140:143], v2, s[36:39], s9 offen offset:2048
    v_mfma_f32_32x32x16_bf16 v[56:71], v[148:151], v[156:159], v[56:71]
    buffer_load_dwordx4 v[144:147], v2, s[36:39], s10 offen offset:2048
    v_mfma_f32_32x32x16_bf16 v[72:87], v[152:155], v[156:159], v[72:87]
    buffer_load_dwordx4 v[148:151], v2, s[36:39], s11 offen offset:2048
    buffer_load_dwordx4 v[152:155], v2, s[36:39], s12 offen offset:2048
    buffer_load_dwordx4 v[156:159], v2, s[36:39], s13 offen offset:2048
    s_waitcnt lgkmcnt(0)
    s_barrier
    s_add_u32 m0, s18, 0
    s_add_u32 s20, s17, 79296
    buffer_load_dwordx4 v2, s[36:39], s17 offen lds
    buffer_load_dwordx4 v2, s[36:39], s20 offen offset:2624 lds
    s_mov_b32 exec_hi, 0xfdffffef
    buffer_load_dwordx4 v160, s[36:39], s17 offen offset:1024 lds
    buffer_load_dwordx4 v160, s[36:39], s20 offen offset:3648 lds
    s_add_u32 m0, s18, 2048
    s_mov_b32 exec_lo, 0xffffbfff
    s_mov_b32 exec_hi, 7
    buffer_load_dwordx4 v161, s[36:39], s17 offen lds
    buffer_load_dwordx4 v161, s[36:39], s20 offen offset:2624 lds
    s_mov_b64 exec, -1
    s_add_u32 s17, s17, 655360
    s_add_u32 m0, s22, 6144
    s_add_u32 s20, s21, 11264
    buffer_load_dwordx4 v2, s[36:39], s20 offen lds
    s_add_u32 m0, s22, 18432
    s_add_u32 s20, s21, 31744
    buffer_load_dwordx4 v2, s[36:39], s20 offen lds
    s_add_u32 m0, s22, 7168
    s_add_u32 s20, s21, 16384
    buffer_load_dwordx4 v2, s[36:39], s20 offen lds
    s_add_u32 m0, s22, 19456
    s_add_u32 s20, s21, 36864
    buffer_load_dwordx4 v2, s[36:39], s20 offen lds
    s_waitcnt vmcnt(22)
    v_mfma_f32_32x32x16_bf16 v[8:23], v[88:91], v[108:111], v[8:23]
    v_mfma_f32_32x32x16_bf16 v[24:39], v[92:95], v[108:111], v[24:39]
    buffer_load_dwordx4 v[88:91], v2, s[36:39], s8 offen offset:3072
    s_add_u32 s8, s8, 4096
    v_mfma_f32_32x32x16_bf16 v[40:55], v[96:99], v[108:111], v[40:55]
    buffer_load_dwordx4 v[92:95], v2, s[36:39], s9 offen offset:3072
    s_add_u32 s9, s9, 4096
    v_mfma_f32_32x32x16_bf16 v[56:71], v[100:103], v[108:111], v[56:71]
    buffer_load_dwordx4 v[96:99], v2, s[36:39], s10 offen offset:3072
    s_add_u32 s10, s10, 4096
    v_mfma_f32_32x32x16_bf16 v[72:87], v[104:107], v[108:111], v[72:87]
    buffer_load_dwordx4 v[100:103], v2, s[36:39], s11 offen offset:3072
    s_add_u32 s11, s11, 4096
    buffer_load_dwordx4 v[104:107], v2, s[36:39], s12 offen offset:3072
    s_add_u32 s12, s12, 4096
    buffer_load_dwordx4 v[108:111], v2, s[36:39], s13 offen offset:3072
    s_add_u32 s13, s13, 4096
    s_waitcnt vmcnt(22)
    v_mfma_f32_32x32x16_bf16 v[8:23], v[112:115], v[132:135], v[8:23]
    v_mfma_f32_32x32x16_bf16 v[24:39], v[116:119], v[132:135], v[24:39]
    buffer_load_dwordx4 v[112:115], v2, s[36:39], s8 offen offset:0
    v_mfma_f32_32x32x16_bf16 v[40:55], v[120:123], v[132:135], v[40:55]
    buffer_load_dwordx4 v[116:119], v2, s[36:39], s9 offen offset:0
    v_mfma_f32_32x32x16_bf16 v[56:71], v[124:127], v[132:135], v[56:71]
    buffer_load_dwordx4 v[120:123], v2, s[36:39], s10 offen offset:0
    v_mfma_f32_32x32x16_bf16 v[72:87], v[128:131], v[132:135], v[72:87]
    buffer_load_dwordx4 v[124:127], v2, s[36:39], s11 offen offset:0
    buffer_load_dwordx4 v[128:131], v2, s[36:39], s12 offen offset:0
    buffer_load_dwordx4 v[132:135], v2, s[36:39], s13 offen offset:0
    s_waitcnt vmcnt(22)
    v_mfma_f32_32x32x16_bf16 v[8:23], v[136:139], v[156:159], v[8:23]
    v_mfma_f32_32x32x16_bf16 v[24:39], v[140:143], v[156:159], v[24:39]
    buffer_load_dwordx4 v[136:139], v2, s[36:39], s8 offen offset:1024
    v_mfma_f32_32x32x16_bf16 v[40:55], v[144:147], v[156:159], v[40:55]
    buffer_load_dwordx4 v[140:143], v2, s[36:39], s9 offen offset:1024
    v_mfma_f32_32x32x16_bf16 v[56:71], v[148:151], v[156:159], v[56:71]
    buffer_load_dwordx4 v[144:147], v2, s[36:39], s10 offen offset:1024
    v_mfma_f32_32x32x16_bf16 v[72:87], v[152:155], v[156:159], v[72:87]
    buffer_load_dwordx4 v[148:151], v2, s[36:39], s11 offen offset:1024
    buffer_load_dwordx4 v[152:155], v2, s[36:39], s12 offen offset:1024
    buffer_load_dwordx4 v[156:159], v2, s[36:39], s13 offen offset:1024
    s_waitcnt vmcnt(12)
    v_mfma_f32_32x32x16_bf16 v[8:23], v[88:91], v[108:111], v[8:23]
    v_mfma_f32_32x32x16_bf16 v[24:39], v[92:95], v[108:111], v[24:39]
    buffer_load_dwordx4 v[88:91], v2, s[36:39], s8 offen offset:2048
    v_mfma_f32_32x32x16_bf16 v[40:55], v[96:99], v[108:111], v[40:55]
    buffer_load_dwordx4 v[92:95], v2, s[36:39], s9 offen offset:2048
    v_mfma_f32_32x32x16_bf16 v[56:71], v[100:103], v[108:111], v[56:71]
    buffer_load_dwordx4 v[96:99], v2, s[36:39], s10 offen offset:2048
    v_mfma_f32_32x32x16_bf16 v[72:87], v[104:107], v[108:111], v[72:87]
    buffer_load_dwordx4 v[100:103], v2, s[36:39], s11 offen offset:2048
    buffer_load_dwordx4 v[104:107], v2, s[36:39], s12 offen offset:2048
    buffer_load_dwordx4 v[108:111], v2, s[36:39], s13 offen offset:2048
    s_barrier
    s_add_u32 m0, s18, 41984
    s_add_u32 s20, s17, 79296
    buffer_load_dwordx4 v2, s[36:39], s17 offen lds
    buffer_load_dwordx4 v2, s[36:39], s20 offen offset:2624 lds
    s_mov_b32 exec_hi, 0xfdffffef
    buffer_load_dwordx4 v160, s[36:39], s17 offen offset:1024 lds
    buffer_load_dwordx4 v160, s[36:39], s20 offen offset:3648 lds
    s_add_u32 m0, s18, 44032
    s_mov_b32 exec_lo, 0xffffbfff
    s_mov_b32 exec_hi, 7
    buffer_load_dwordx4 v161, s[36:39], s17 offen lds
    buffer_load_dwordx4 v161, s[36:39], s20 offen offset:2624 lds
    s_mov_b64 exec, -1
    s_add_u32 s17, s17, 655360
    s_add_u32 m0, s22, 8192
    s_add_u32 s20, s21, 2048
    buffer_load_dwordx4 v2, s[36:39], s20 offen lds
    s_add_u32 m0, s22, 20480
    s_add_u32 s20, s21, 22528
    buffer_load_dwordx4 v2, s[36:39], s20 offen lds
    s_add_u32 m0, s22, 9216
    s_add_u32 s20, s21, 7168
    buffer_load_dwordx4 v2, s[36:39], s20 offen lds
    s_add_u32 m0, s22, 21504
    s_add_u32 s20, s21, 27648
    buffer_load_dwordx4 v2, s[36:39], s20 offen lds
    s_waitcnt vmcnt(22)
    v_mfma_f32_32x32x16_bf16 v[8:23], v[112:115], v[132:135], v[8:23]
    v_mfma_f32_32x32x16_bf16 v[24:39], v[116:119], v[132:135], v[24:39]
    buffer_load_dwordx4 v[112:115], v2, s[36:39], s8 offen offset:3072
    s_add_u32 s8, s8, 4096
    v_mfma_f32_32x32x16_bf16 v[40:55], v[120:123], v[132:135], v[40:55]
    buffer_load_dwordx4 v[116:119], v2, s[36:39], s9 offen offset:3072
    s_add_u32 s9, s9, 4096
    v_mfma_f32_32x32x16_bf16 v[56:71], v[124:127], v[132:135], v[56:71]
    buffer_load_dwordx4 v[120:123], v2, s[36:39], s10 offen offset:3072
    s_add_u32 s10, s10, 4096
    v_mfma_f32_32x32x16_bf16 v[72:87], v[128:131], v[132:135], v[72:87]
    buffer_load_dwordx4 v[124:127], v2, s[36:39], s11 offen offset:3072
    s_add_u32 s11, s11, 4096
    buffer_load_dwordx4 v[128:131], v2, s[36:39], s12 offen offset:3072
    s_add_u32 s12, s12, 4096
    buffer_load_dwordx4 v[132:135], v2, s[36:39], s13 offen offset:3072
    s_add_u32 s13, s13, 4096
    s_waitcnt vmcnt(22)
    v_mfma_f32_32x32x16_bf16 v[8:23], v[136:139], v[156:159], v[8:23]
    v_mfma_f32_32x32x16_bf16 v[24:39], v[140:143], v[156:159], v[24:39]
    buffer_load_dwordx4 v[136:139], v2, s[36:39], s8 offen offset:0
    v_mfma_f32_32x32x16_bf16 v[40:55], v[144:147], v[156:159], v[40:55]
    buffer_load_dwordx4 v[140:143], v2, s[36:39], s9 offen offset:0
    v_mfma_f32_32x32x16_bf16 v[56:71], v[148:151], v[156:159], v[56:71]
    buffer_load_dwordx4 v[144:147], v2, s[36:39], s10 offen offset:0
    v_mfma_f32_32x32x16_bf16 v[72:87], v[152:155], v[156:159], v[72:87]
    buffer_load_dwordx4 v[148:151], v2, s[36:39], s11 offen offset:0
    buffer_load_dwordx4 v[152:155], v2, s[36:39], s12 offen offset:0
    buffer_load_dwordx4 v[156:159], v2, s[36:39], s13 offen offset:0
    s_waitcnt vmcnt(22)
    v_mfma_f32_32x32x16_bf16 v[8:23], v[88:91], v[108:111], v[8:23]
    v_mfma_f32_32x32x16_bf16 v[24:39], v[92:95], v[108:111], v[24:39]
    buffer_load_dwordx4 v[88:91], v2, s[36:39], s8 offen offset:1024
    v_mfma_f32_32x32x16_bf16 v[40:55], v[96:99], v[108:111], v[40:55]
    buffer_load_dwordx4 v[92:95], v2, s[36:39], s9 offen offset:1024
    v_mfma_f32_32x32x16_bf16 v[56:71], v[100:103], v[108:111], v[56:71]
    buffer_load_dwordx4 v[96:99], v2, s[36:39], s10 offen offset:1024
    v_mfma_f32_32x32x16_bf16 v[72:87], v[104:107], v[108:111], v[72:87]
    buffer_load_dwordx4 v[100:103], v2, s[36:39], s11 offen offset:1024
    buffer_load_dwordx4 v[104:107], v2, s[36:39], s12 offen offset:1024
    buffer_load_dwordx4 v[108:111], v2, s[36:39], s13 offen offset:1024
    s_waitcnt vmcnt(22)
    s_barrier
    s_add_u32 m0, s16, 24576
    s_add_u32 s20, s21, 3072
    buffer_load_dwordx4 v2, s[36:39], s20 offen lds
    s_add_u32 m0, s16, 25600
    s_add_u32 s20, s21, 23552
    buffer_load_dwordx4 v2, s[36:39], s20 offen lds
    s_add_u32 m0, s16, 32768
    s_add_u32 s20, s21, 8192
    buffer_load_dwordx4 v2, s[36:39], s20 offen lds
    s_add_u32 m0, s16, 33792
    s_add_u32 s20, s21, 28672
    buffer_load_dwordx4 v2, s[36:39], s20 offen lds
    s_add_u32 m0, s22, 10240
    s_add_u32 s20, s21, 12288
    buffer_load_dwordx4 v2, s[36:39], s20 offen lds
    s_add_u32 m0, s22, 22528
    s_add_u32 s20, s21, 32768
    buffer_load_dwordx4 v2, s[36:39], s20 offen lds
    s_add_u32 m0, s22, 11264
    s_add_u32 s20, s21, 17408
    buffer_load_dwordx4 v2, s[36:39], s20 offen lds
    s_add_u32 m0, s22, 23552
    s_add_u32 s20, s21, 37888
    buffer_load_dwordx4 v2, s[36:39], s20 offen lds
    s_waitcnt vmcnt(20)
    v_mfma_f32_32x32x16_bf16 v[8:23], v[112:115], v[132:135], v[8:23]
    v_mfma_f32_32x32x16_bf16 v[24:39], v[116:119], v[132:135], v[24:39]
    buffer_load_dwordx4 v[112:115], v2, s[36:39], s8 offen offset:2048
    v_mfma_f32_32x32x16_bf16 v[40:55], v[120:123], v[132:135], v[40:55]
    buffer_load_dwordx4 v[116:119], v2, s[36:39], s9 offen offset:2048
    v_mfma_f32_32x32x16_bf16 v[56:71], v[124:127], v[132:135], v[56:71]
    buffer_load_dwordx4 v[120:123], v2, s[36:39], s10 offen offset:2048
    v_mfma_f32_32x32x16_bf16 v[72:87], v[128:131], v[132:135], v[72:87]
    buffer_load_dwordx4 v[124:127], v2, s[36:39], s11 offen offset:2048
    buffer_load_dwordx4 v[128:131], v2, s[36:39], s12 offen offset:2048
    buffer_load_dwordx4 v[132:135], v2, s[36:39], s13 offen offset:2048
    s_waitcnt vmcnt(20)
    v_mfma_f32_32x32x16_bf16 v[8:23], v[136:139], v[156:159], v[8:23]
    v_mfma_f32_32x32x16_bf16 v[24:39], v[140:143], v[156:159], v[24:39]
    buffer_load_dwordx4 v[136:139], v2, s[36:39], s8 offen offset:3072
    s_add_u32 s8, s8, 4096
    v_mfma_f32_32x32x16_bf16 v[40:55], v[144:147], v[156:159], v[40:55]
    buffer_load_dwordx4 v[140:143], v2, s[36:39], s9 offen offset:3072
    s_add_u32 s9, s9, 4096
    v_mfma_f32_32x32x16_bf16 v[56:71], v[148:151], v[156:159], v[56:71]
    buffer_load_dwordx4 v[144:147], v2, s[36:39], s10 offen offset:3072
    s_add_u32 s10, s10, 4096
    v_mfma_f32_32x32x16_bf16 v[72:87], v[152:155], v[156:159], v[72:87]
    buffer_load_dwordx4 v[148:151], v2, s[36:39], s11 offen offset:3072
    s_add_u32 s11, s11, 4096
    buffer_load_dwordx4 v[152:155], v2, s[36:39], s12 offen offset:3072
    s_add_u32 s12, s12, 4096
    buffer_load_dwordx4 v[156:159], v2, s[36:39], s13 offen offset:3072
    s_add_u32 s13, s13, 4096
    s_waitcnt vmcnt(20)
    v_mfma_f32_32x32x16_bf16 v[8:23], v[88:91], v[108:111], v[8:23]
    s_add_u32 s20, s21, 19456
    buffer_load_dwordx4 v[160:163], v2, s[36:39], s20 offen
    v_mfma_f32_32x32x16_bf16 v[24:39], v[92:95], v[108:111], v[24:39]
    s_add_u32 s20, s21, 40960
    buffer_load_dwordx4 v[88:91], v2, s[36:39], s20 offen
    v_mfma_f32_32x32x16_bf16 v[40:55], v[96:99], v[108:111], v[40:55]
    s_add_u32 s20, s21, 41984
    buffer_load_dwordx4 v[92:95], v2, s[36:39], s20 offen
    v_mfma_f32_32x32x16_bf16 v[56:71], v[100:103], v[108:111], v[56:71]
    s_add_u32 s20, s21, 43008
    buffer_load_dwordx4 v[96:99], v2, s[36:39], s20 offen
    v_mfma_f32_32x32x16_bf16 v[72:87], v[104:107], v[108:111], v[72:87]
    s_add_u32 s20, s21, 44032
    buffer_load_dwordx4 v[100:103], v2, s[36:39], s20 offen
    s_add_u32 s20, s21, 45056
    buffer_load_dwordx4 v[104:107], v2, s[36:39], s20 offen
    s_add_u32 s20, s21, 14336
    buffer_load_dwordx4 v[108:111], v2, s[36:39], s20 offen
    s_waitcnt vmcnt(13)
    v_mfma_f32_32x32x16_bf16 v[8:23], v[112:115], v[132:135], v[8:23]
    s_add_u32 s20, s21, 39936
    buffer_load_dwordx4 v[164:167], v2, s[36:39], s20 offen
    v_mfma_f32_32x32x16_bf16 v[24:39], v[116:119], v[132:135], v[24:39]
    s_add_u32 s20, s21, 46080
    buffer_load_dwordx4 v[112:115], v2, s[36:39], s20 offen
    v_mfma_f32_32x32x16_bf16 v[40:55], v[120:123], v[132:135], v[40:55]
    s_add_u32 s20, s21, 47104
    buffer_load_dwordx4 v[116:119], v2, s[36:39], s20 offen
    v_mfma_f32_32x32x16_bf16 v[56:71], v[124:127], v[132:135], v[56:71]
    s_add_u32 s20, s21, 48128
    buffer_load_dwordx4 v[120:123], v2, s[36:39], s20 offen
    v_mfma_f32_32x32x16_bf16 v[72:87], v[128:131], v[132:135], v[72:87]
    s_add_u32 s20, s21, 49152
    buffer_load_dwordx4 v[124:127], v2, s[36:39], s20 offen
    s_add_u32 s20, s21, 50176
    buffer_load_dwordx4 v[128:131], v2, s[36:39], s20 offen
    s_add_u32 s20, s21, 34816
    buffer_load_dwordx4 v[132:135], v2, s[36:39], s20 offen
    v_mov_b32 v1, 0
    s_mov_b64 exec, 1
    buffer_atomic_add v1, v0, s[36:39], s24 offen sc0 sc1
    s_mov_b64 exec, -1
    s_waitcnt vmcnt(15)
    ds_read_b32 v6, v2 offset:64592
    v_mfma_f32_32x32x16_bf16 v[8:23], v[136:139], v[156:159], v[8:23]
    v_mfma_f32_32x32x16_bf16 v[24:39], v[140:143], v[156:159], v[24:39]
    v_mfma_f32_32x32x16_bf16 v[40:55], v[144:147], v[156:159], v[40:55]
    v_mfma_f32_32x32x16_bf16 v[56:71], v[148:151], v[156:159], v[56:71]
    v_mfma_f32_32x32x16_bf16 v[72:87], v[152:155], v[156:159], v[72:87]
    s_mov_b32 s26, 0
    s_add_u32 s17, s25, 5120
    s_branch KF_POLL_E
KF_LDMA:
    s_add_u32 m0, s16, 0
    s_add_u32 s20, s21, 13312
    buffer_load_dwordx4 v2, s[36:39], s20 offen lds
    s_add_u32 m0, s16, 1024
    s_add_u32 s20, s21, 33792
    buffer_load_dwordx4 v2, s[36:39], s20 offen lds
    s_add_u32 m0, s16, 8192
    s_add_u32 s20, s21, 18432
    buffer_load_dwordx4 v2, s[36:39], s20 offen lds
    s_add_u32 m0, s16, 9216
    s_add_u32 s20, s21, 38912
    buffer_load_dwordx4 v2, s[36:39], s20 offen lds
    s_add_u32 m0, s16, 16384
    s_add_u32 s20, s21, 4096
    buffer_load_dwordx4 v2, s[36:39], s20 offen lds
    s_add_u32 m0, s16, 17408
    s_add_u32 s20, s21, 24576
    buffer_load_dwordx4 v2, s[36:39], s20 offen lds
    s_add_u32 m0, s16, 40960
    s_add_u32 s20, s21, 9216
    buffer_load_dwordx4 v2, s[36:39], s20 offen lds
    s_add_u32 m0, s16, 41984
    s_add_u32 s20, s21, 29696
    buffer_load_dwordx4 v2, s[36:39], s20 offen lds
    s_mov_b32 s15, 1
    s_setpc_b64 s[4:5]
KF_POLL:
    v_mov_b32 v1, 0
    s_mov_b64 exec, 1
    buffer_atomic_add v1, v0, s[36:39], s24 offen sc0 sc1
    s_mov_b64 exec, -1
    ds_read_b32 v6, v2 offset:64592
KF_POLL_E:
    s_cmp_lg_u32 s15, 0
    s_cbranch_scc1 KF_POLL_W
    s_waitcnt lgkmcnt(0)
    v_readfirstlane_b32 s20, v6
    s_cmp_lt_u32 s20, 8
    s_cbranch_scc1 KF_POLL_W
    s_call_b64 s[4:5], KF_LDMA
    s_waitcnt vmcnt(8)
    s_branch KF_POLL_C
KF_POLL_W:
    s_waitcnt vmcnt(0)
KF_POLL_C:
    v_readfirstlane_b32 s23, v1
    s_add_u32 s26, s26, 1
    s_cmp_gt_u32 s26, 400000
    s_cbranch_scc1 KF_POLL_DONE
    s_and_b32 s20, s23, 0x404
    s_cbranch_scc0 KF_POLL
KF_POLL_DONE:
    s_waitcnt lgkmcnt(0)
    s_bitcmp1_b32 s23, 2
    s_cselect_b32 s18, s25, s17
    s_cselect_b32 s17, s17, s25
    buffer_load_dwordx2 v[152:153], v7, s[36:39], s18 offen offset:1024 sc0 sc1
    buffer_load_dwordx2 v[154:155], v7, s[36:39], s18 offen offset:2304 sc0 sc1
    buffer_load_dwordx4 v[136:139], v2, s[36:39], s18 offen offset:0 sc0 sc1
    buffer_load_dwordx4 v[140:143], v2, s[36:39], s18 offen offset:1280 sc0 sc1
    buffer_load_dwordx4 v[144:147], v2, s[36:39], s18 offen offset:2560 sc0 sc1
    buffer_load_dwordx4 v[148:151], v2, s[36:39], s18 offen offset:3840 sc0 sc1
    v_mov_b32 v6, 0
    s_mov_b64 exec, 1
    buffer_atomic_add v6, v0, s[36:39], s24 offen sc0 sc1
    s_mov_b64 exec, -1
    s_cselect_b32 s19, 0x400, 4
    s_cselect_b32 s8, 0, 12288
    s_cselect_b32 s9, 0, 1024
    s_add_u32 s10, s22, s8
    s_add_u32 s11, s16, s9
    v_add_u32 v1, s10, v2
    s_nop 3
    v_pk_mul_f32 v[8:9], v[8:9], v[4:5]
    v_pk_mul_f32 v[10:11], v[10:11], v[4:5]
    v_pk_mul_f32 v[12:13], v[12:13], v[4:5]
    v_pk_mul_f32 v[14:15], v[14:15], v[4:5]
    v_pk_mul_f32 v[16:17], v[16:17], v[4:5]
    v_pk_mul_f32 v[18:19], v[18:19], v[4:5]
    v_pk_mul_f32 v[20:21], v[20:21], v[4:5]
    v_pk_mul_f32 v[22:23], v[22:23], v[4:5]
    v_pk_mul_f32 v[24:25], v[24:25], v[4:5]
    v_pk_mul_f32 v[26:27], v[26:27], v[4:5]
    v_pk_mul_f32 v[28:29], v[28:29], v[4:5]
    v_pk_mul_f32 v[30:31], v[30:31], v[4:5]
    v_pk_mul_f32 v[32:33], v[32:33], v[4:5]
    v_pk_mul_f32 v[34:35], v[34:35], v[4:5]
    v_pk_mul_f32 v[36:37], v[36:37], v[4:5]
    v_pk_mul_f32 v[38:39], v[38:39], v[4:5]
    v_pk_mul_f32 v[40:41], v[40:41], v[4:5]
    v_pk_mul_f32 v[42:43], v[42:43], v[4:5]
    v_pk_mul_f32 v[44:45], v[44:45], v[4:5]
    v_pk_mul_f32 v[46:47], v[46:47], v[4:5]
    v_pk_mul_f32 v[48:49], v[48:49], v[4:5]
    v_pk_mul_f32 v[50:51], v[50:51], v[4:5]
    v_pk_mul_f32 v[52:53], v[52:53], v[4:5]
    v_pk_mul_f32 v[54:55], v[54:55], v[4:5]
    v_pk_mul_f32 v[56:57], v[56:57], v[4:5]
    v_pk_mul_f32 v[58:59], v[58:59], v[4:5]
    v_pk_mul_f32 v[60:61], v[60:61], v[4:5]
    v_pk_mul_f32 v[62:63], v[62:63], v[4:5]
    v_pk_mul_f32 v[64:65], v[64:65], v[4:5]
    v_pk_mul_f32 v[66:67], v[66:67], v[4:5]
    v_pk_mul_f32 v[68:69], v[68:69], v[4:5]
    v_pk_mul_f32 v[70:71], v[70:71], v[4:5]
    v_pk_mul_f32 v[72:73], v[72:73], v[4:5]
    v_pk_mul_f32 v[74:75], v[74:75], v[4:5]
    v_pk_mul_f32 v[76:77], v[76:77], v[4:5]
    v_pk_mul_f32 v[78:79], v[78:79], v[4:5]
    v_pk_mul_f32 v[80:81], v[80:81], v[4:5]
    v_pk_mul_f32 v[82:83], v[82:83], v[4:5]
    v_pk_mul_f32 v[84:85], v[84:85], v[4:5]
    v_pk_mul_f32 v[86:87], v[86:87], v[4:5]
    s_cmp_eq_u32 s9, 0
    s_waitcnt vmcnt(7)
    s_cbranch_scc1 KF_NOSWAP
    v_swap_b32 v88, v112
    v_swap_b32 v89, v113
    v_swap_b32 v90, v114
    v_swap_b32 v91, v115
    v_swap_b32 v92, v116
    v_swap_b32 v93, v117
    v_swap_b32 v94, v118
    v_swap_b32 v95, v119
    v_swap_b32 v96, v120
    v_swap_b32 v97, v121
    v_swap_b32 v98, v122
    v_swap_b32 v99, v123
    v_swap_b32 v100, v124
    v_swap_b32 v101, v125
    v_swap_b32 v102, v126
    v_swap_b32 v103, v127
    v_swap_b32 v104, v128
    v_swap_b32 v105, v129
    v_swap_b32 v106, v130
    v_swap_b32 v107, v131
    v_swap_b32 v108, v132
    v_swap_b32 v109, v133
    v_swap_b32 v110, v134
    v_swap_b32 v111, v135
    v_swap_b32 v160, v164
    v_swap_b32 v161, v165
    v_swap_b32 v162, v166
    v_swap_b32 v163, v167
KF_NOSWAP:
    ds_read_b128 v[156:159], v1 offset:0
    s_branch KF_CHK1
KF_RETRY1:
    buffer_load_dwordx2 v[152:153], v7, s[36:39], s18 offen offset:1024 sc0 sc1
    buffer_load_dwordx2 v[154:155], v7, s[36:39], s18 offen offset:2304 sc0 sc1
    buffer_load_dwordx4 v[136:139], v2, s[36:39], s18 offen offset:0 sc0 sc1
    buffer_load_dwordx4 v[140:143], v2, s[36:39], s18 offen offset:1280 sc0 sc1
    buffer_load_dwordx4 v[144:147], v2, s[36:39], s18 offen offset:2560 sc0 sc1
    buffer_load_dwordx4 v[148:151], v2, s[36:39], s18 offen offset:3840 sc0 sc1
    v_mov_b32 v6, 0
    s_mov_b64 exec, 1
    buffer_atomic_add v6, v0, s[36:39], s24 offen sc0 sc1
    s_mov_b64 exec, -1
KF_CHK1:
    s_waitcnt vmcnt(0)
    v_max3_u32 v5, v136, v137, v138
    v_max3_u32 v5, v5, v139, v140
    v_max3_u32 v5, v5, v141, v142
    v_max3_u32 v5, v5, v143, v144
    v_max3_u32 v5, v5, v145, v146
    v_max3_u32 v5, v5, v147, v148
    v_max3_u32 v5, v5, v149, v150
    v_max3_u32 v5, v5, v151, v152
    v_max3_u32 v5, v5, v153, v154
    v_max_u32 v5, v5, v155
    v_cmp_eq_u32 vcc, -1, v5
    s_add_u32 s26, s26, 1
    s_cmp_gt_u32 s26, 400000
    s_cbranch_scc1 KF_RETRY1_DONE
    s_cbranch_vccnz KF_RETRY1
KF_RETRY1_DONE:
    ds_read_b32 v5, v2 offset:64592
    v_mfma_f32_32x32x16_bf16 v[8:23], v[88:91], v[152:155], v[8:23]
    v_readfirstlane_b32 s23, v6
    v_add_u32 v6, s11, v2
    v_mfma_f32_32x32x16_bf16 v[24:39], v[92:95], v[152:155], v[24:39]
    v_mfma_f32_32x32x16_bf16 v[40:55], v[96:99], v[152:155], v[40:55]
    s_cmp_lg_u32 s15, 0
    s_cbranch_scc1 KF_T2
    s_waitcnt lgkmcnt(0)
    v_readfirstlane_b32 s20, v5
    s_cmp_lt_u32 s20, 8
    s_cbranch_scc1 KF_T2
    s_call_b64 s[4:5], KF_LDMA
KF_T2:
    v_mfma_f32_32x32x16_bf16 v[56:71], v[100:103], v[152:155], v[56:71]
    v_mfma_f32_32x32x16_bf16 v[72:87], v[104:107], v[152:155], v[72:87]
    v_mfma_f32_32x32x16_bf16 v[72:87], v[108:111], v[144:147], v[72:87]
    ds_read_b128 v[152:155], v1 offset:1024
    v_mov_b32 v4, 0
    s_and_b32 s20, s23, s19
    s_cbranch_scc1 KF_BOTH
    s_mov_b64 exec, 1
    buffer_atomic_add v4, v0, s[36:39], s24 offen sc0 sc1
    s_mov_b64 exec, -1
    s_branch KF_PH1
KF_BOTH:
    buffer_load_dwordx2 v[104:105], v7, s[36:39], s17 offen offset:1024 sc0 sc1
    buffer_load_dwordx2 v[106:107], v7, s[36:39], s17 offen offset:2304 sc0 sc1
    buffer_load_dwordx4 v[88:91], v2, s[36:39], s17 offen offset:0 sc0 sc1
    buffer_load_dwordx4 v[92:95], v2, s[36:39], s17 offen offset:1280 sc0 sc1
    buffer_load_dwordx4 v[96:99], v2, s[36:39], s17 offen offset:2560 sc0 sc1
    buffer_load_dwordx4 v[100:103], v2, s[36:39], s17 offen offset:3840 sc0 sc1
    s_mov_b32 s19, 0
KF_PH1:
    v_mfma_f32_32x32x16_bf16 v[72:87], v[160:163], v[148:151], v[72:87]
    ds_read_b128 v[108:111], v1 offset:2048
    s_waitcnt lgkmcnt(3)
    v_mfma_f32_32x32x16_bf16 v[8:23], v[156:159], v[136:139], v[8:23]
    ds_read_b128 v[160:163], v1 offset:3072
    s_waitcnt lgkmcnt(2)
    v_mfma_f32_32x32x16_bf16 v[8:23], v[152:155], v[140:143], v[8:23]
    ds_read_b128 v[156:159], v1 offset:4096
    s_waitcnt lgkmcnt(2)
    v_mfma_f32_32x32x16_bf16 v[8:23], v[108:111], v[144:147], v[8:23]
    ds_read_b128 v[152:155], v1 offset:5120
    s_waitcnt lgkmcnt(2)
    v_mfma_f32_32x32x16_bf16 v[8:23], v[160:163], v[148:151], v[8:23]
    ds_read_b128 v[108:111], v1 offset:6144
    s_waitcnt lgkmcnt(2)
    v_mfma_f32_32x32x16_bf16 v[24:39], v[156:159], v[136:139], v[24:39]
    ds_read_b128 v[160:163], v1 offset:7168
    s_waitcnt lgkmcnt(2)
    v_mfma_f32_32x32x16_bf16 v[24:39], v[152:155], v[140:143], v[24:39]
    ds_read_b128 v[156:159], v1 offset:8192
    s_waitcnt lgkmcnt(2)
    v_mfma_f32_32x32x16_bf16 v[24:39], v[108:111], v[144:147], v[24:39]
    ds_read_b128 v[152:155], v1 offset:9216
    s_waitcnt lgkmcnt(2)
    v_mfma_f32_32x32x16_bf16 v[24:39], v[160:163], v[148:151], v[24:39]
    ds_read_b128 v[108:111], v1 offset:10240
    s_waitcnt lgkmcnt(2)
    v_mfma_f32_32x32x16_bf16 v[40:55], v[156:159], v[136:139], v[40:55]
    ds_read_b128 v[160:163], v1 offset:11264
    s_waitcnt lgkmcnt(2)
    v_mfma_f32_32x32x16_bf16 v[40:55], v[152:155], v[140:143], v[40:55]
    ds_read_b128 v[156:159], v6 offset:24576
    s_waitcnt lgkmcnt(2)
    v_mfma_f32_32x32x16_bf16 v[40:55], v[108:111], v[144:147], v[40:55]
    ds_read_b128 v[152:155], v6 offset:32768
    s_cmp_eq_u32 s15, 0
    s_cbranch_scc1 KF_T3
    s_waitcnt vmcnt(6)
    s_cmp_eq_u32 s19, 0
    s_cbranch_scc1 KF_T3X
    s_waitcnt vmcnt(1)
    s_branch KF_T3X
KF_T3:
    ds_read_b32 v5, v2 offset:64592
    s_add_u32 s26, s26, 1
    s_cmp_gt_u32 s26, 400000
    s_cbranch_scc1 KF_T3X
    s_cmp_lg_u32 s15, 0
    s_cbranch_scc1 KF_T3
    s_waitcnt lgkmcnt(0)
    v_readfirstlane_b32 s20, v5
    s_cmp_lt_u32 s20, 8
    s_cbranch_scc1 KF_T3
    s_call_b64 s[4:5], KF_LDMA
    s_waitcnt vmcnt(0)
KF_T3X:
    s_waitcnt lgkmcnt(2)
    v_mfma_f32_32x32x16_bf16 v[40:55], v[160:163], v[148:151], v[40:55]
    ds_read_b128 v[108:111], v6 offset:0
    s_waitcnt lgkmcnt(2)
    v_mfma_f32_32x32x16_bf16 v[56:71], v[156:159], v[136:139], v[56:71]
    ds_read_b128 v[160:163], v6 offset:8192
    s_waitcnt lgkmcnt(2)
    v_mfma_f32_32x32x16_bf16 v[56:71], v[152:155], v[140:143], v[56:71]
    ds_read_b128 v[156:159], v6 offset:16384
    s_waitcnt lgkmcnt(2)
    v_mfma_f32_32x32x16_bf16 v[56:71], v[108:111], v[144:147], v[56:71]
    ds_read_b128 v[152:155], v6 offset:40960
    v_xor_b32 v6, 1024, v6
    s_sub_u32 s10, s22, s8
    s_add_u32 s10, s10, 12288
    v_add_u32 v1, s10, v2
    s_waitcnt lgkmcnt(2)
    v_mfma_f32_32x32x16_bf16 v[56:71], v[160:163], v[148:151], v[56:71]
    ds_read_b128 v[108:111], v1 offset:0
    ds_read_b128 v[144:147], v1 offset:1024
    s_waitcnt lgkmcnt(3)
    v_mfma_f32_32x32x16_bf16 v[72:87], v[156:159], v[136:139], v[72:87]
    ds_read_b128 v[160:163], v1 offset:2048
    ds_read_b128 v[148:151], v1 offset:3072
    s_waitcnt lgkmcnt(4)
    v_mfma_f32_32x32x16_bf16 v[72:87], v[152:155], v[140:143], v[72:87]
    ds_read_b128 v[156:159], v1 offset:4096
    ds_read_b128 v[136:139], v1 offset:5120
    s_nop 7
    ds_read_b128 v[152:155], v1 offset:6144
    ds_read_b128 v[140:143], v1 offset:7168
    s_cmp_eq_u32 s19, 0
    s_cbranch_scc1 KF_PH2
    s_mov_b64 exec, 1
    s_branch KF_POLLB_W
KF_POLLB:
    v_mov_b32 v4, 0
    buffer_atomic_add v4, v0, s[36:39], s24 offen sc0 sc1
KF_POLLB_W:
    s_add_u32 s26, s26, 1
    s_waitcnt vmcnt(0)
    v_readfirstlane_b32 s23, v4
    s_cmp_gt_u32 s26, 400000
    s_cbranch_scc1 KF_POLLB_DONE
    s_and_b32 s20, s23, s19
    s_cbranch_scc0 KF_POLLB
KF_POLLB_DONE:
    s_mov_b64 exec, -1
KF_RETRY2:
    buffer_load_dwordx2 v[104:105], v7, s[36:39], s17 offen offset:1024 sc0 sc1
    buffer_load_dwordx2 v[106:107], v7, s[36:39], s17 offen offset:2304 sc0 sc1
    buffer_load_dwordx4 v[88:91], v2, s[36:39], s17 offen offset:0 sc0 sc1
    buffer_load_dwordx4 v[92:95], v2, s[36:39], s17 offen offset:1280 sc0 sc1
    buffer_load_dwordx4 v[96:99], v2, s[36:39], s17 offen offset:2560 sc0 sc1
    buffer_load_dwordx4 v[100:103], v2, s[36:39], s17 offen offset:3840 sc0 sc1
KF_PH2:
    s_waitcnt vmcnt(0)
    v_max3_u32 v5, v88, v89, v90
    v_max3_u32 v5, v5, v91, v92
    v_max3_u32 v5, v5, v93, v94
    v_max3_u32 v5, v5, v95, v96
    v_max3_u32 v5, v5, v97, v98
    v_max3_u32 v5, v5, v99, v100
    v_max3_u32 v5, v5, v101, v102
    v_max3_u32 v5, v5, v103, v104
    v_max3_u32 v5, v5, v105, v106
    v_max_u32 v5, v5, v107
    v_cmp_eq_u32 vcc, -1, v5
    s_add_u32 s26, s26, 1
    s_cmp_gt_u32 s26, 400000
    s_cbranch_scc1 KF_RETRY2_DONE
    s_cbranch_vccnz KF_RETRY2
KF_RETRY2_DONE:
    v_mfma_f32_32x32x16_bf16 v[8:23], v[112:115], v[104:107], v[8:23]
    s_lshl_b32 s20, 1, s7
    v_mov_b32 v5, s20
    s_waitcnt lgkmcnt(7)
    v_mfma_f32_32x32x16_bf16 v[8:23], v[108:111], v[88:91], v[8:23]
    ds_read_b128 v[112:115], v1 offset:8192
    s_waitcnt lgkmcnt(7)
    v_mfma_f32_32x32x16_bf16 v[8:23], v[144:147], v[92:95], v[8:23]
    ds_read_b128 v[108:111], v1 offset:9216
    s_waitcnt lgkmcnt(7)
    v_mfma_f32_32x32x16_bf16 v[8:23], v[160:163], v[96:99], v[8:23]
    ds_read_b128 v[144:147], v1 offset:10240
    s_waitcnt lgkmcnt(7)
    v_mfma_f32_32x32x16_bf16 v[8:23], v[148:151], v[100:103], v[8:23]
    ds_read_b128 v[160:163], v1 offset:11264
    v_mfma_f32_32x32x16_bf16 v[24:39], v[116:119], v[104:107], v[24:39]
    ds_read_b128 v[148:151], v6 offset:24576
    s_waitcnt lgkmcnt(8)
    v_mfma_f32_32x32x16_bf16 v[24:39], v[156:159], v[88:91], v[24:39]
    ds_read_b128 v[116:119], v6 offset:32768
    s_waitcnt lgkmcnt(8)
    v_mfma_f32_32x32x16_bf16 v[24:39], v[136:139], v[92:95], v[24:39]
    ds_write_b128 v3, v[8:11] offset:0
    s_waitcnt lgkmcnt(8)
    v_mfma_f32_32x32x16_bf16 v[24:39], v[152:155], v[96:99], v[24:39]
    ds_write_b128 v3, v[12:15] offset:32
    s_waitcnt lgkmcnt(8)
    v_mfma_f32_32x32x16_bf16 v[24:39], v[140:143], v[100:103], v[24:39]
    ds_write_b128 v3, v[16:19] offset:64
    v_mfma_f32_32x32x16_bf16 v[40:55], v[120:123], v[104:107], v[40:55]
    ds_write_b128 v3, v[20:23] offset:96
    s_waitcnt lgkmcnt(9)
    v_mfma_f32_32x32x16_bf16 v[40:55], v[112:115], v[88:91], v[40:55]
    s_mov_b64 exec, 1
    ds_or_b32 v0, v5 offset:64512
    s_mov_b64 exec, -1
    ds_read_b128 v[156:159], v6 offset:0
    ds_read_b128 v[136:139], v6 offset:8192
    s_waitcnt lgkmcnt(11)
    v_mfma_f32_32x32x16_bf16 v[40:55], v[108:111], v[92:95], v[40:55]
    ds_write_b128 v3, v[24:27] offset:4608
    s_waitcnt lgkmcnt(11)
    v_mfma_f32_32x32x16_bf16 v[40:55], v[144:147], v[96:99], v[40:55]
    ds_write_b128 v3, v[28:31] offset:4640
    s_waitcnt lgkmcnt(11)
    v_mfma_f32_32x32x16_bf16 v[40:55], v[160:163], v[100:103], v[40:55]
    ds_write_b128 v3, v[32:35] offset:4672
    v_mfma_f32_32x32x16_bf16 v[56:71], v[124:127], v[104:107], v[56:71]
    ds_write_b128 v3, v[36:39] offset:4704
    s_waitcnt lgkmcnt(12)
    v_mfma_f32_32x32x16_bf16 v[56:71], v[148:151], v[88:91], v[56:71]
    s_mov_b64 exec, 1
    ds_or_b32 v0, v5 offset:64528
    s_mov_b64 exec, -1
    ds_read_b128 v[152:155], v6 offset:16384
    ds_read_b128 v[140:143], v6 offset:40960
    s_waitcnt lgkmcnt(14)
    v_mfma_f32_32x32x16_bf16 v[56:71], v[116:119], v[92:95], v[56:71]
    ds_write_b128 v3, v[40:43] offset:9216
    s_waitcnt lgkmcnt(9)
    v_mfma_f32_32x32x16_bf16 v[56:71], v[156:159], v[96:99], v[56:71]
    ds_write_b128 v3, v[44:47] offset:9248
    s_waitcnt lgkmcnt(9)
    v_mfma_f32_32x32x16_bf16 v[56:71], v[136:139], v[100:103], v[56:71]
    ds_write_b128 v3, v[48:51] offset:9280
    v_mfma_f32_32x32x16_bf16 v[72:87], v[128:131], v[104:107], v[72:87]
    ds_write_b128 v3, v[52:55] offset:9312
    s_waitcnt lgkmcnt(5)
    v_mfma_f32_32x32x16_bf16 v[72:87], v[152:155], v[88:91], v[72:87]
    s_mov_b64 exec, 1
    ds_or_b32 v0, v5 offset:64544
    s_mov_b64 exec, -1
    s_waitcnt lgkmcnt(5)
    v_mfma_f32_32x32x16_bf16 v[72:87], v[140:143], v[92:95], v[72:87]
    ds_write_b128 v3, v[56:59] offset:13824
    v_mfma_f32_32x32x16_bf16 v[72:87], v[132:135], v[96:99], v[72:87]
    ds_write_b128 v3, v[60:63] offset:13856
    v_mfma_f32_32x32x16_bf16 v[72:87], v[164:167], v[100:103], v[72:87]
    ds_write_b128 v3, v[64:67] offset:13888
    ds_write_b128 v3, v[68:71] offset:13920
    s_mov_b64 exec, 1
    ds_or_b32 v0, v5 offset:64560
    s_mov_b64 exec, -1
    s_nop 6
    ds_write_b128 v3, v[72:75] offset:18432
    ds_write_b128 v3, v[76:79] offset:18464
    ds_write_b128 v3, v[80:83] offset:18496
    ds_write_b128 v3, v[84:87] offset:18528
    s_mov_b64 exec, 1
    ds_or_b32 v0, v5 offset:64576
    s_mov_b64 exec, -1
    s_branch KF_DONE
KF_COMPUTE:
    s_and_b32 s8, s3, 3
    s_lshr_b32 s9, s3, 2
    s_lshl_b32 s10, s8, 12
    v_lshlrev_b32 v5, 7, v3
    v_add_u32 v5, s10, v5
    v_bfe_u32 v6, v3, 1, 3
    v_xor_b32 v6, v6, v4
    v_lshl_add_u32 v5, v6, 4, v5
    s_lshl_b32 s10, s9, 5
    v_xor_b32 v10, s10, v5
    v_xor_b32 v11, 32, v10
    v_xor_b32 v12, 64, v10
    v_xor_b32 v13, 0x60, v10
    v_bfe_u32 v5, v0, 2, 2
    v_lshl_add_u32 v6, v4, 3, v5
    v_bfe_u32 v7, v0, 4, 1
    v_and_b32 v8, 3, v0
    v_lshlrev_b32 v7, 5, v7
    v_lshl_add_u32 v7, v8, 3, v7
    v_lshl_add_u32 v8, v6, 8, v7
    v_lshl_add_u32 v8, v5, 6, v8
    s_lshl_b32 s11, s9, 7
    v_xor_b32 v8, s11, v8
    s_lshl_b32 s11, s9, 12
    s_add_u32 s12, s11, 16384
    s_sub_u32 s13, 16384, s11
    v_add_u32 v14, s12, v8
    v_add_u32 v16, s13, v8
    v_xor_b32 v15, 64, v14
    v_xor_b32 v17, 64, v16
    v_xor_b32 v7, s10, v7
    v_lshlrev_b32 v8, 7, v6
    v_bfe_u32 v6, v0, 3, 1
    v_lshl_add_u32 v7, v6, 6, v7
    s_lshl_b32 s11, s9, 11
    s_add_u32 s11, s11, 98304
    v_add3_u32 v18, v8, v7, s11
    v_xor_b32 v1, 64, v18
    s_mov_b32 s64, 0xbfb8aa3b
    s_mov_b32 s65, 0xbfb8aa3b
    s_mov_b32 s66, 1.0
    s_mov_b32 s67, 1.0
    s_lshl_b32 s10, s4, 2
    s_add_u32 s8, s10, s8
    s_mul_i32 s12, s8, 96
    s_mul_i32 s13, s5, 6
    s_add_u32 s12, s12, s13
    s_add_u32 s12, s12, s9
    s_and_b32 s13, s5, 1
    s_lshl_b32 s13, s13, 1
    s_add_u32 s12, s12, s13
    s_lshl_b32 s12, s12, 10
    s_add_u32 s12, s12, 0x900000
    s_bfe_u32 s10, s4, 0x10001
    s_lshl_b32 s10, s10, 3
    s_and_b32 s13, s4, 1
    s_or_b32 s10, s10, s13
    s_lshr_b32 s13, s4, 2
    s_lshl1_add_u32 s10, s13, s10
    s_sub_u32 s13, s5, 5
    s_cmp_lt_u32 s13, 10
    s_cmov_b32 s4, s10
    s_and_b32 s8, s3, 3
    s_lshl2_add_u32 s8, s4, s8
    s_cmp_lt_u32 s5, 5
    s_mov_b32 s14, 1280
    s_cmov_b32 s14, 81920
    s_mov_b32 s13, 81920
    s_cmov_b32 s13, 1280
    s_cselect_b32 s15, 0, 0x300000
    s_cselect_b32 s68, 0x3ea52b5c, 1.0
    s_cselect_b32 s10, 0, 5
    s_mov_b32 s69, s68
    s_mul_i32 s13, s8, s13
    s_add_u32 s15, s15, s13
    v_mul_lo_u32 v5, v4, s14
    v_lshl_add_u32 v5, v3, 3, v5
    v_add_u32 v19, 1024, v5
    s_sub_u32 s10, s5, s10
    s_lshl_b32 s10, s10, 1
    s_add_u32 s10, s10, s9
    s_mov_b32 s6, 0
    s_cmp_eq_u32 s10, 0
    s_cmov_b32 s6, 0x200820
    s_cmp_eq_u32 s10, 1
    s_cmov_b32 s6, 0x2621483
    s_cmp_eq_u32 s10, 2
    s_cmov_b32 s6, 0x832507
    s_cmp_eq_u32 s10, 3
    s_cmov_b32 s6, 0x465316a
    s_cmp_eq_u32 s10, 4
    s_cmov_b32 s6, 0xe63dcd
    s_cmp_eq_u32 s10, 5
    s_cmov_b32 s6, 0x1284a30
    s_cmp_eq_u32 s10, 6
    s_cmov_b32 s6, 0x16a5693
    s_cmp_eq_u32 s10, 7
    s_cmov_b32 s6, 0x39c62f6
    s_cmp_eq_u32 s10, 8
    s_cmov_b32 s6, 0x1cd737a
    s_cmp_eq_u32 s10, 9
    s_cmov_b32 s6, 0x59f7fdd
    s_lshr_b32 s7, s6, 25
    s_lshl_b32 s13, s7, 3
    s_sub_u32 s13, s13, 8
    v_add_u32 v5, s13, v2
    s_cmp_eq_u32 s7, 0
    s_cselect_b64 vcc, -1, 0
    s_lshl_b32 s11, s3, 11
    v_cndmask_b32 v9, v5, v19, vcc
    s_waitcnt lgkmcnt(0)
    s_mov_b32 s36, s34
    s_mov_b32 s37, s35
    s_mov_b32 s40, s30
    s_mov_b32 s41, s31
    s_mov_b32 s60, s32
    s_mov_b32 s61, s33
    s_lshl_b32 s13, s2, 4
    s_or_b32 s13, s13, s3
    s_cmp_lg_u32 s13, 2055
    s_cbranch_scc1 KF_NOZERO
    v_lshlrev_b32 v5, 6, v0
    v_mov_b32 v6, 0
    v_mov_b32 v7, 1
    s_mov_b32 s13, 0x1a04000
    buffer_store_dword v6, v5, s[36:39], s13 offen sc1
    s_add_u32 s13, s13, 4096
    buffer_store_dword v6, v5, s[36:39], s13 offen sc1
    s_add_u32 s13, s13, 4096
    buffer_store_dword v6, v5, s[36:39], s13 offen sc1
    s_add_u32 s13, s13, 4096
    buffer_store_dword v6, v5, s[36:39], s13 offen sc1
    s_add_u32 s13, s13, 4096
    buffer_store_dword v6, v5, s[36:39], s13 offen sc1
    s_add_u32 s13, s13, 4096
    buffer_store_dword v6, v5, s[36:39], s13 offen sc1
    s_mov_b64 exec, 15
    s_waitcnt vmcnt(0)
    buffer_atomic_add v7, v5, s[60:63], 0 offen sc1
    s_mov_b64 exec, -1
    v_mul_u32_u24 v5, 64, v0
    s_mov_b32 s13, 0x1b00000
    buffer_store_dword v6, v5, s[36:39], s13 offen sc1
    s_add_u32 s13, s13, 4096
    buffer_store_dword v6, v5, s[36:39], s13 offen sc1
    s_add_u32 s13, s13, 4096
    buffer_store_dword v6, v5, s[36:39], s13 offen sc1
    s_add_u32 s13, s13, 4096
    buffer_store_dword v6, v5, s[36:39], s13 offen sc1
    s_add_u32 s13, s13, 4096
KF_NOZERO:
    s_sub_u32 s7, s10, 10
    s_lshl_b32 s7, s7, 12
    s_add_u32 s7, s7, s15
    s_add_u32 s7, s7, 40960
    s_sub_u32 s13, s5, 10
    s_cmp_lt_u32 s13, 5
    s_cselect_b32 s22, 1, 0
    s_bfe_u32 s13, s6, 0x50000
    s_mul_i32 s13, s13, s14
    s_add_u32 s13, s13, s15
    s_cmp_eq_u32 s22, 1
    s_cselect_b32 s16, s7, s13
    s_add_u32 s7, s7, 1024
    s_bfe_u32 s13, s6, 0x50005
    s_mul_i32 s13, s13, s14
    s_add_u32 s13, s13, s15
    s_cmp_eq_u32 s22, 1
    s_cselect_b32 s17, s7, s13
    s_add_u32 s7, s7, 1024
    s_bfe_u32 s13, s6, 0x5000a
    s_mul_i32 s13, s13, s14
    s_add_u32 s13, s13, s15
    s_cmp_eq_u32 s22, 1
    s_cselect_b32 s18, s7, s13
    s_add_u32 s7, s7, 1024
    s_bfe_u32 s13, s6, 0x5000f
    s_mul_i32 s13, s13, s14
    s_add_u32 s13, s13, s15
    s_cmp_eq_u32 s22, 1
    s_cselect_b32 s19, s7, s13
    s_add_u32 s7, s7, 1024
    s_bfe_u32 s13, s6, 0x50014
    s_mul_i32 s13, s13, s14
    s_add_u32 s13, s13, s15
    s_cmp_eq_u32 s22, 1
    s_cselect_b32 s20, s7, s13
    s_add_u32 s7, s7, 1024
    s_mov_b32 s24, 0x40000
    s_mov_b32 s23, 0
    s_mov_b32 s31, 0xff
    s_mul_i32 s30, s4, 1024
    s_add_u32 s30, s30, 0x1a06000
    s_mov_b32 s29, 0x1a04000
    s_call_b64 s[26:27], KF_ACK
    s_mov_b32 s24, 63488
    s_cmp_ge_u32 s4, 2
    s_cselect_b32 s10, 1, 0
    s_cmp_ge_u32 s4, 6
    s_cmov_b32 s10, 2
    s_cmp_lt_u32 s5, 5
    s_cmov_b32 s10, 0
    s_cmp_eq_u32 s10, 0
    s_cselect_b32 s21, 0, 64
    s_cmp_eq_u32 s5, 15
    s_cmov_b32 s10, 3
    s_cmov_b32 s21, 0
    s_bitcmp1_b32 s5, 0
    s_movk_i32 s28, 4096
    s_cmov_b32 s28, -2048
    s_lshl_b32 s23, 1, s4
    s_mul_i32 s29, s5, 512
    s_add_u32 s29, s29, 0x1a04000
    s_cmp_eq_u32 s22, 1
    s_barrier
    s_cbranch_scc1 KF_P1V
    ds_read_b128 v[20:23], v10 offset:32768
    ds_read_b64_tr_b16 v[132:133], v14 offset:32768
    ds_read_b64_tr_b16 v[134:135], v14 offset:33792
    ds_read_b64_tr_b16 v[136:137], v15 offset:32768
    ds_read_b64_tr_b16 v[138:139], v15 offset:33792
    ds_read_b128 v[156:159], v11 offset:32768
    ds_read_b64_tr_b16 v[148:149], v16 offset:36864
    ds_read_b64_tr_b16 v[150:151], v16 offset:37888
    ds_read_b64_tr_b16 v[152:153], v17 offset:36864
    ds_read_b64_tr_b16 v[154:155], v17 offset:37888
    s_waitcnt lgkmcnt(7)
    v_mfma_f32_32x32x16_bf16 v[100:115], v[132:135], v[20:23], 0
    ds_read_b128 v[24:27], v12 offset:32768
    ds_read_b64_tr_b16 v[140:141], v14 offset:40960
    ds_read_b64_tr_b16 v[142:143], v14 offset:41984
    s_waitcnt lgkmcnt(8)
    v_mfma_f32_32x32x16_bf16 v[116:131], v[136:139], v[20:23], 0
    ds_read_b64_tr_b16 v[144:145], v15 offset:40960
    ds_read_b64_tr_b16 v[146:147], v15 offset:41984
    s_waitcnt lgkmcnt(7)
    v_mfma_f32_32x32x16_bf16 v[100:115], v[148:151], v[156:159], v[100:115]
    ds_read_b128 v[160:163], v13 offset:32768
    ds_read_b64_tr_b16 v[132:133], v16 offset:45056
    ds_read_b64_tr_b16 v[134:135], v16 offset:46080
    s_waitcnt lgkmcnt(8)
    v_mfma_f32_32x32x16_bf16 v[116:131], v[152:155], v[156:159], v[116:131]
    ds_read_b64_tr_b16 v[136:137], v17 offset:45056
    ds_read_b64_tr_b16 v[138:139], v17 offset:46080
    s_waitcnt lgkmcnt(7)
    v_mfma_f32_32x32x16_bf16 v[100:115], v[140:143], v[24:27], v[100:115]
    s_barrier
    ds_read_b128 v[28:31], v10 offset:0
    ds_read_b64_tr_b16 v[148:149], v14 offset:0
    ds_read_b64_tr_b16 v[150:151], v14 offset:1024
    s_waitcnt lgkmcnt(8)
    v_mfma_f32_32x32x16_bf16 v[116:131], v[144:147], v[24:27], v[116:131]
    ds_read_b64_tr_b16 v[152:153], v15 offset:0
    ds_read_b64_tr_b16 v[154:155], v15 offset:1024
    s_waitcnt lgkmcnt(7)
    v_mfma_f32_32x32x16_bf16 v[100:115], v[132:135], v[160:163], v[100:115]
    ds_read_b128 v[156:159], v11 offset:0
    ds_read_b64_tr_b16 v[140:141], v16 offset:4096
    ds_read_b64_tr_b16 v[142:143], v16 offset:5120
    s_waitcnt lgkmcnt(8)
    v_mfma_f32_32x32x16_bf16 v[116:131], v[136:139], v[160:163], v[116:131]
    ds_read_b64_tr_b16 v[144:145], v17 offset:4096
    ds_read_b64_tr_b16 v[146:147], v17 offset:5120
    s_waitcnt lgkmcnt(7)
    v_mfma_f32_32x32x16_bf16 v[100:115], v[148:151], v[28:31], v[100:115]
    ds_read_b128 v[32:35], v12 offset:0
    ds_read_b64_tr_b16 v[132:133], v14 offset:8192
    ds_read_b64_tr_b16 v[134:135], v14 offset:9216
    s_waitcnt lgkmcnt(8)
    v_mfma_f32_32x32x16_bf16 v[116:131], v[152:155], v[28:31], v[116:131]
    ds_read_b64_tr_b16 v[136:137], v15 offset:8192
    ds_read_b64_tr_b16 v[138:139], v15 offset:9216
    s_waitcnt lgkmcnt(7)
    v_mfma_f32_32x32x16_bf16 v[100:115], v[140:143], v[156:159], v[100:115]
    ds_read_b128 v[160:163], v13 offset:0
    ds_read_b64_tr_b16 v[148:149], v16 offset:12288
    ds_read_b64_tr_b16 v[150:151], v16 offset:13312
    s_waitcnt lgkmcnt(8)
    v_mfma_f32_32x32x16_bf16 v[116:131], v[144:147], v[156:159], v[116:131]
    ds_read_b64_tr_b16 v[152:153], v17 offset:12288
    ds_read_b64_tr_b16 v[154:155], v17 offset:13312
    s_waitcnt lgkmcnt(7)
    v_mfma_f32_32x32x16_bf16 v[100:115], v[132:135], v[32:35], v[100:115]
    s_barrier
    v_add_u32 v10, 0x10000, v10
    v_add_u32 v11, 0x10000, v11
    v_add_u32 v12, 0x10000, v12
    v_add_u32 v13, 0x10000, v13
    v_add_u32 v14, 0x10000, v14
    v_add_u32 v15, 0x10000, v15
    v_add_u32 v16, 0x10000, v16
    v_add_u32 v17, 0x10000, v17
    ds_read_b128 v[36:39], v10 offset:32768
    ds_read_b64_tr_b16 v[140:141], v14 offset:32768
    ds_read_b64_tr_b16 v[142:143], v14 offset:33792
    s_waitcnt lgkmcnt(8)
    v_mfma_f32_32x32x16_bf16 v[116:131], v[136:139], v[32:35], v[116:131]
    ds_read_b64_tr_b16 v[144:145], v15 offset:32768
    ds_read_b64_tr_b16 v[146:147], v15 offset:33792
    s_waitcnt lgkmcnt(7)
    v_mfma_f32_32x32x16_bf16 v[100:115], v[148:151], v[160:163], v[100:115]
    ds_read_b128 v[156:159], v11 offset:32768
    ds_read_b64_tr_b16 v[132:133], v16 offset:36864
    ds_read_b64_tr_b16 v[134:135], v16 offset:37888
    s_waitcnt lgkmcnt(8)
    v_mfma_f32_32x32x16_bf16 v[116:131], v[152:155], v[160:163], v[116:131]
    ds_read_b64_tr_b16 v[136:137], v17 offset:36864
    ds_read_b64_tr_b16 v[138:139], v17 offset:37888
    s_waitcnt lgkmcnt(7)
    v_mfma_f32_32x32x16_bf16 v[100:115], v[140:143], v[36:39], v[100:115]
    ds_read_b128 v[40:43], v12 offset:32768
    ds_read_b64_tr_b16 v[148:149], v14 offset:40960
    ds_read_b64_tr_b16 v[150:151], v14 offset:41984
    s_waitcnt lgkmcnt(8)
    v_mfma_f32_32x32x16_bf16 v[116:131], v[144:147], v[36:39], v[116:131]
    ds_read_b64_tr_b16 v[152:153], v15 offset:40960
    ds_read_b64_tr_b16 v[154:155], v15 offset:41984
    s_waitcnt lgkmcnt(7)
    v_mfma_f32_32x32x16_bf16 v[100:115], v[132:135], v[156:159], v[100:115]
    ds_read_b128 v[160:163], v13 offset:32768
    ds_read_b64_tr_b16 v[140:141], v16 offset:45056
    ds_read_b64_tr_b16 v[142:143], v16 offset:46080
    s_waitcnt lgkmcnt(8)
    v_mfma_f32_32x32x16_bf16 v[116:131], v[136:139], v[156:159], v[116:131]
    ds_read_b64_tr_b16 v[144:145], v17 offset:45056
    ds_read_b64_tr_b16 v[146:147], v17 offset:46080
    s_waitcnt lgkmcnt(7)
    v_mfma_f32_32x32x16_bf16 v[100:115], v[148:151], v[40:43], v[100:115]
    s_barrier
    ds_read_b128 v[44:47], v10 offset:0
    ds_read_b64_tr_b16 v[132:133], v14 offset:0
    ds_read_b64_tr_b16 v[134:135], v14 offset:1024
    s_waitcnt lgkmcnt(8)
    v_mfma_f32_32x32x16_bf16 v[116:131], v[152:155], v[40:43], v[116:131]
    ds_read_b64_tr_b16 v[136:137], v15 offset:0
    ds_read_b64_tr_b16 v[138:139], v15 offset:1024
    s_waitcnt lgkmcnt(7)
    v_mfma_f32_32x32x16_bf16 v[100:115], v[140:143], v[160:163], v[100:115]
    ds_read_b128 v[156:159], v11 offset:0
    ds_read_b64_tr_b16 v[148:149], v16 offset:4096
    ds_read_b64_tr_b16 v[150:151], v16 offset:5120
    s_waitcnt lgkmcnt(8)
    v_mfma_f32_32x32x16_bf16 v[116:131], v[144:147], v[160:163], v[116:131]
    ds_read_b64_tr_b16 v[152:153], v17 offset:4096
    ds_read_b64_tr_b16 v[154:155], v17 offset:5120
    s_waitcnt lgkmcnt(7)
    v_mfma_f32_32x32x16_bf16 v[100:115], v[132:135], v[44:47], v[100:115]
    ds_read_b128 v[48:51], v12 offset:0
    ds_read_b64_tr_b16 v[140:141], v14 offset:8192
    ds_read_b64_tr_b16 v[142:143], v14 offset:9216
    s_waitcnt lgkmcnt(8)
    v_mfma_f32_32x32x16_bf16 v[116:131], v[136:139], v[44:47], v[116:131]
    ds_read_b64_tr_b16 v[144:145], v15 offset:8192
    ds_read_b64_tr_b16 v[146:147], v15 offset:9216
    s_waitcnt lgkmcnt(7)
    v_mfma_f32_32x32x16_bf16 v[100:115], v[148:151], v[156:159], v[100:115]
    ds_read_b128 v[160:163], v13 offset:0
    ds_read_b64_tr_b16 v[132:133], v16 offset:12288
    ds_read_b64_tr_b16 v[134:135], v16 offset:13312
    s_waitcnt lgkmcnt(8)
    v_mfma_f32_32x32x16_bf16 v[116:131], v[152:155], v[156:159], v[116:131]
    ds_read_b64_tr_b16 v[136:137], v17 offset:12288
    ds_read_b64_tr_b16 v[138:139], v17 offset:13312
    s_waitcnt lgkmcnt(7)
    v_mfma_f32_32x32x16_bf16 v[100:115], v[140:143], v[48:51], v[100:115]
    s_barrier
    v_add_u32 v10, 0xffff0000, v10
    v_add_u32 v11, 0xffff0000, v11
    v_add_u32 v12, 0xffff0000, v12
    v_add_u32 v13, 0xffff0000, v13
    v_add_u32 v14, 0xffff0000, v14
    v_add_u32 v15, 0xffff0000, v15
    v_add_u32 v16, 0xffff0000, v16
    v_add_u32 v17, 0xffff0000, v17
    ds_read_b128 v[52:55], v10 offset:32768
    ds_read_b64_tr_b16 v[148:149], v14 offset:32768
    ds_read_b64_tr_b16 v[150:151], v14 offset:33792
    s_waitcnt lgkmcnt(8)
    v_mfma_f32_32x32x16_bf16 v[116:131], v[144:147], v[48:51], v[116:131]
    ds_read_b64_tr_b16 v[152:153], v15 offset:32768
    ds_read_b64_tr_b16 v[154:155], v15 offset:33792
    s_waitcnt lgkmcnt(7)
    v_mfma_f32_32x32x16_bf16 v[100:115], v[132:135], v[160:163], v[100:115]
    ds_read_b128 v[156:159], v11 offset:32768
    ds_read_b64_tr_b16 v[140:141], v16 offset:36864
    ds_read_b64_tr_b16 v[142:143], v16 offset:37888
    s_waitcnt lgkmcnt(8)
    v_mfma_f32_32x32x16_bf16 v[116:131], v[136:139], v[160:163], v[116:131]
    ds_read_b64_tr_b16 v[144:145], v17 offset:36864
    ds_read_b64_tr_b16 v[146:147], v17 offset:37888
    s_waitcnt lgkmcnt(7)
    v_mfma_f32_32x32x16_bf16 v[100:115], v[148:151], v[52:55], v[100:115]
    ds_read_b128 v[56:59], v12 offset:32768
    ds_read_b64_tr_b16 v[132:133], v14 offset:40960
    ds_read_b64_tr_b16 v[134:135], v14 offset:41984
    s_waitcnt lgkmcnt(8)
    v_mfma_f32_32x32x16_bf16 v[116:131], v[152:155], v[52:55], v[116:131]
    ds_read_b64_tr_b16 v[136:137], v15 offset:40960
    ds_read_b64_tr_b16 v[138:139], v15 offset:41984
    s_waitcnt lgkmcnt(7)
    v_mfma_f32_32x32x16_bf16 v[100:115], v[140:143], v[156:159], v[100:115]
    ds_read_b128 v[160:163], v13 offset:32768
    ds_read_b64_tr_b16 v[148:149], v16 offset:45056
    ds_read_b64_tr_b16 v[150:151], v16 offset:46080
    s_waitcnt lgkmcnt(8)
    v_mfma_f32_32x32x16_bf16 v[116:131], v[144:147], v[156:159], v[116:131]
    ds_read_b64_tr_b16 v[152:153], v17 offset:45056
    ds_read_b64_tr_b16 v[154:155], v17 offset:46080
    s_waitcnt lgkmcnt(7)
    v_mfma_f32_32x32x16_bf16 v[100:115], v[132:135], v[56:59], v[100:115]
    s_barrier
    ds_read_b128 v[60:63], v10 offset:0
    ds_read_b64_tr_b16 v[140:141], v14 offset:0
    ds_read_b64_tr_b16 v[142:143], v14 offset:1024
    s_waitcnt lgkmcnt(8)
    v_mfma_f32_32x32x16_bf16 v[116:131], v[136:139], v[56:59], v[116:131]
    ds_read_b64_tr_b16 v[144:145], v15 offset:0
    ds_read_b64_tr_b16 v[146:147], v15 offset:1024
    s_waitcnt lgkmcnt(7)
    v_mfma_f32_32x32x16_bf16 v[100:115], v[148:151], v[160:163], v[100:115]
    ds_read_b128 v[156:159], v11 offset:0
    ds_read_b64_tr_b16 v[132:133], v16 offset:4096
    ds_read_b64_tr_b16 v[134:135], v16 offset:5120
    s_waitcnt lgkmcnt(8)
    v_mfma_f32_32x32x16_bf16 v[116:131], v[152:155], v[160:163], v[116:131]
    ds_read_b64_tr_b16 v[136:137], v17 offset:4096
    ds_read_b64_tr_b16 v[138:139], v17 offset:5120
    s_waitcnt lgkmcnt(7)
    v_mfma_f32_32x32x16_bf16 v[100:115], v[140:143], v[60:63], v[100:115]
    ds_read_b128 v[64:67], v12 offset:0
    ds_read_b64_tr_b16 v[148:149], v14 offset:8192
    ds_read_b64_tr_b16 v[150:151], v14 offset:9216
    s_waitcnt lgkmcnt(8)
    v_mfma_f32_32x32x16_bf16 v[116:131], v[144:147], v[60:63], v[116:131]
    ds_read_b64_tr_b16 v[152:153], v15 offset:8192
    ds_read_b64_tr_b16 v[154:155], v15 offset:9216
    s_waitcnt lgkmcnt(7)
    v_mfma_f32_32x32x16_bf16 v[100:115], v[132:135], v[156:159], v[100:115]
    ds_read_b128 v[160:163], v13 offset:0
    ds_read_b64_tr_b16 v[140:141], v16 offset:12288
    ds_read_b64_tr_b16 v[142:143], v16 offset:13312
    s_waitcnt lgkmcnt(8)
    v_mfma_f32_32x32x16_bf16 v[116:131], v[136:139], v[156:159], v[116:131]
    ds_read_b64_tr_b16 v[144:145], v17 offset:12288
    ds_read_b64_tr_b16 v[146:147], v17 offset:13312
    s_waitcnt lgkmcnt(7)
    v_mfma_f32_32x32x16_bf16 v[100:115], v[148:151], v[64:67], v[100:115]
    s_barrier
    v_add_u32 v10, 0x10000, v10
    v_add_u32 v11, 0x10000, v11
    v_add_u32 v12, 0x10000, v12
    v_add_u32 v13, 0x10000, v13
    v_add_u32 v14, 0x10000, v14
    v_add_u32 v15, 0x10000, v15
    v_add_u32 v16, 0x10000, v16
    v_add_u32 v17, 0x10000, v17
    ds_read_b128 v[68:71], v10 offset:32768
    ds_read_b64_tr_b16 v[132:133], v14 offset:32768
    ds_read_b64_tr_b16 v[134:135], v14 offset:33792
    s_waitcnt lgkmcnt(8)
    v_mfma_f32_32x32x16_bf16 v[116:131], v[152:155], v[64:67], v[116:131]
    ds_read_b64_tr_b16 v[136:137], v15 offset:32768
    ds_read_b64_tr_b16 v[138:139], v15 offset:33792
    s_waitcnt lgkmcnt(7)
    v_mfma_f32_32x32x16_bf16 v[100:115], v[140:143], v[160:163], v[100:115]
    ds_read_b128 v[156:159], v11 offset:32768
    ds_read_b64_tr_b16 v[148:149], v16 offset:36864
    ds_read_b64_tr_b16 v[150:151], v16 offset:37888
    s_waitcnt lgkmcnt(8)
    v_mfma_f32_32x32x16_bf16 v[116:131], v[144:147], v[160:163], v[116:131]
    ds_read_b64_tr_b16 v[152:153], v17 offset:36864
    ds_read_b64_tr_b16 v[154:155], v17 offset:37888
    s_waitcnt lgkmcnt(7)
    v_mfma_f32_32x32x16_bf16 v[100:115], v[132:135], v[68:71], v[100:115]
    ds_read_b128 v[72:75], v12 offset:32768
    ds_read_b64_tr_b16 v[140:141], v14 offset:40960
    ds_read_b64_tr_b16 v[142:143], v14 offset:41984
    s_waitcnt lgkmcnt(8)
    v_mfma_f32_32x32x16_bf16 v[116:131], v[136:139], v[68:71], v[116:131]
    ds_read_b64_tr_b16 v[144:145], v15 offset:40960
    ds_read_b64_tr_b16 v[146:147], v15 offset:41984
    s_waitcnt lgkmcnt(7)
    v_mfma_f32_32x32x16_bf16 v[100:115], v[148:151], v[156:159], v[100:115]
    ds_read_b128 v[160:163], v13 offset:32768
    ds_read_b64_tr_b16 v[132:133], v16 offset:45056
    ds_read_b64_tr_b16 v[134:135], v16 offset:46080
    s_waitcnt lgkmcnt(8)
    v_mfma_f32_32x32x16_bf16 v[116:131], v[152:155], v[156:159], v[116:131]
    ds_read_b64_tr_b16 v[136:137], v17 offset:45056
    ds_read_b64_tr_b16 v[138:139], v17 offset:46080
    s_waitcnt lgkmcnt(7)
    v_mfma_f32_32x32x16_bf16 v[100:115], v[140:143], v[72:75], v[100:115]
    s_barrier
    ds_read_b128 v[76:79], v10 offset:0
    ds_read_b64_tr_b16 v[148:149], v14 offset:0
    ds_read_b64_tr_b16 v[150:151], v14 offset:1024
    s_waitcnt lgkmcnt(8)
    v_mfma_f32_32x32x16_bf16 v[116:131], v[144:147], v[72:75], v[116:131]
    ds_read_b64_tr_b16 v[152:153], v15 offset:0
    ds_read_b64_tr_b16 v[154:155], v15 offset:1024
    s_waitcnt lgkmcnt(7)
    v_mfma_f32_32x32x16_bf16 v[100:115], v[132:135], v[160:163], v[100:115]
    ds_read_b128 v[156:159], v11 offset:0
    ds_read_b64_tr_b16 v[140:141], v16 offset:4096
    ds_read_b64_tr_b16 v[142:143], v16 offset:5120
    s_waitcnt lgkmcnt(8)
    v_mfma_f32_32x32x16_bf16 v[116:131], v[136:139], v[160:163], v[116:131]
    ds_read_b64_tr_b16 v[144:145], v17 offset:4096
    ds_read_b64_tr_b16 v[146:147], v17 offset:5120
    s_waitcnt lgkmcnt(7)
    v_mfma_f32_32x32x16_bf16 v[100:115], v[148:151], v[76:79], v[100:115]
    ds_read_b128 v[80:83], v12 offset:0
    ds_read_b64_tr_b16 v[132:133], v14 offset:8192
    ds_read_b64_tr_b16 v[134:135], v14 offset:9216
    s_waitcnt lgkmcnt(8)
    v_mfma_f32_32x32x16_bf16 v[116:131], v[152:155], v[76:79], v[116:131]
    ds_read_b64_tr_b16 v[136:137], v15 offset:8192
    ds_read_b64_tr_b16 v[138:139], v15 offset:9216
    s_waitcnt lgkmcnt(7)
    v_mfma_f32_32x32x16_bf16 v[100:115], v[140:143], v[156:159], v[100:115]
    ds_read_b128 v[160:163], v13 offset:0
    ds_read_b64_tr_b16 v[148:149], v16 offset:12288
    ds_read_b64_tr_b16 v[150:151], v16 offset:13312
    s_waitcnt lgkmcnt(8)
    v_mfma_f32_32x32x16_bf16 v[116:131], v[144:147], v[156:159], v[116:131]
    ds_read_b64_tr_b16 v[152:153], v17 offset:12288
    ds_read_b64_tr_b16 v[154:155], v17 offset:13312
    s_waitcnt lgkmcnt(7)
    v_mfma_f32_32x32x16_bf16 v[100:115], v[132:135], v[80:83], v[100:115]
    s_waitcnt vmcnt(0)
    s_barrier
    v_add_u32 v10, 0xffff0000, v10
    v_add_u32 v11, 0xffff0000, v11
    v_add_u32 v12, 0xffff0000, v12
    v_add_u32 v13, 0xffff0000, v13
    v_add_u32 v14, 0xffff0000, v14
    v_add_u32 v15, 0xffff0000, v15
    v_add_u32 v16, 0xffff0000, v16
    v_add_u32 v17, 0xffff0000, v17
    ds_read_b128 v[84:87], v10 offset:32768
    ds_read_b64_tr_b16 v[140:141], v14 offset:32768
    ds_read_b64_tr_b16 v[142:143], v14 offset:33792
    s_waitcnt lgkmcnt(8)
    v_mfma_f32_32x32x16_bf16 v[116:131], v[136:139], v[80:83], v[116:131]
    ds_read_b64_tr_b16 v[144:145], v15 offset:32768
    ds_read_b64_tr_b16 v[146:147], v15 offset:33792
    s_waitcnt lgkmcnt(7)
    v_mfma_f32_32x32x16_bf16 v[100:115], v[148:151], v[160:163], v[100:115]
    ds_read_b128 v[156:159], v11 offset:32768
    ds_read_b64_tr_b16 v[132:133], v16 offset:36864
    ds_read_b64_tr_b16 v[134:135], v16 offset:37888
    s_waitcnt lgkmcnt(8)
    v_mfma_f32_32x32x16_bf16 v[116:131], v[152:155], v[160:163], v[116:131]
    ds_read_b64_tr_b16 v[136:137], v17 offset:36864
    ds_read_b64_tr_b16 v[138:139], v17 offset:37888
    s_waitcnt lgkmcnt(7)
    v_mfma_f32_32x32x16_bf16 v[100:115], v[140:143], v[84:87], v[100:115]
    ds_read_b128 v[88:91], v12 offset:32768
    ds_read_b64_tr_b16 v[148:149], v14 offset:40960
    ds_read_b64_tr_b16 v[150:151], v14 offset:41984
    s_waitcnt lgkmcnt(8)
    v_mfma_f32_32x32x16_bf16 v[116:131], v[144:147], v[84:87], v[116:131]
    ds_read_b64_tr_b16 v[152:153], v15 offset:40960
    ds_read_b64_tr_b16 v[154:155], v15 offset:41984
    s_waitcnt lgkmcnt(7)
    v_mfma_f32_32x32x16_bf16 v[100:115], v[132:135], v[156:159], v[100:115]
    ds_read_b128 v[160:163], v13 offset:32768
    ds_read_b64_tr_b16 v[140:141], v16 offset:45056
    ds_read_b64_tr_b16 v[142:143], v16 offset:46080
    s_waitcnt lgkmcnt(8)
    v_mfma_f32_32x32x16_bf16 v[116:131], v[136:139], v[156:159], v[116:131]
    ds_read_b64_tr_b16 v[144:145], v17 offset:45056
    ds_read_b64_tr_b16 v[146:147], v17 offset:46080
    s_waitcnt lgkmcnt(7)
    v_mfma_f32_32x32x16_bf16 v[100:115], v[148:151], v[88:91], v[100:115]
    s_barrier
    ds_read_b128 v[92:95], v10 offset:0
    ds_read_b64_tr_b16 v[132:133], v14 offset:0
    ds_read_b64_tr_b16 v[134:135], v14 offset:1024
    s_waitcnt lgkmcnt(8)
    v_mfma_f32_32x32x16_bf16 v[116:131], v[152:155], v[88:91], v[116:131]
    ds_read_b64_tr_b16 v[136:137], v15 offset:0
    ds_read_b64_tr_b16 v[138:139], v15 offset:1024
    s_waitcnt lgkmcnt(7)
    v_mfma_f32_32x32x16_bf16 v[100:115], v[140:143], v[160:163], v[100:115]
    ds_read_b128 v[156:159], v11 offset:0
    ds_read_b64_tr_b16 v[148:149], v16 offset:4096
    ds_read_b64_tr_b16 v[150:151], v16 offset:5120
    s_waitcnt lgkmcnt(8)
    v_mfma_f32_32x32x16_bf16 v[116:131], v[144:147], v[160:163], v[116:131]
    ds_read_b64_tr_b16 v[152:153], v17 offset:4096
    ds_read_b64_tr_b16 v[154:155], v17 offset:5120
    s_waitcnt lgkmcnt(7)
    v_mfma_f32_32x32x16_bf16 v[100:115], v[132:135], v[92:95], v[100:115]
    ds_read_b128 v[96:99], v12 offset:0
    ds_read_b64_tr_b16 v[140:141], v14 offset:8192
    ds_read_b64_tr_b16 v[142:143], v14 offset:9216
    s_waitcnt lgkmcnt(8)
    v_mfma_f32_32x32x16_bf16 v[116:131], v[136:139], v[92:95], v[116:131]
    ds_read_b64_tr_b16 v[144:145], v15 offset:8192
    ds_read_b64_tr_b16 v[146:147], v15 offset:9216
    s_waitcnt lgkmcnt(7)
    v_mfma_f32_32x32x16_bf16 v[100:115], v[148:151], v[156:159], v[100:115]
    ds_read_b128 v[160:163], v13 offset:0
    ds_read_b64_tr_b16 v[132:133], v16 offset:12288
    ds_read_b64_tr_b16 v[134:135], v16 offset:13312
    s_waitcnt lgkmcnt(8)
    v_mfma_f32_32x32x16_bf16 v[116:131], v[152:155], v[156:159], v[116:131]
    ds_read_b64_tr_b16 v[136:137], v17 offset:12288
    ds_read_b64_tr_b16 v[138:139], v17 offset:13312
    s_waitcnt lgkmcnt(7)
    v_mfma_f32_32x32x16_bf16 v[100:115], v[140:143], v[96:99], v[100:115]
    s_barrier
    ds_read_b64_tr_b16 v[148:149], v18 offset:61440
    ds_read_b64_tr_b16 v[150:151], v18 offset:61952
    s_waitcnt lgkmcnt(7)
    v_mfma_f32_32x32x16_bf16 v[116:131], v[144:147], v[96:99], v[116:131]
    ds_read_b64_tr_b16 v[152:153], v18 offset:57344
    ds_read_b64_tr_b16 v[154:155], v18 offset:57856
    s_waitcnt lgkmcnt(6)
    v_mfma_f32_32x32x16_bf16 v[100:115], v[132:135], v[160:163], v[100:115]
    ds_read_b64_tr_b16 v[156:157], v1 offset:61440
    ds_read_b64_tr_b16 v[158:159], v1 offset:61952
    s_waitcnt lgkmcnt(6)
    v_mfma_f32_32x32x16_bf16 v[116:131], v[136:139], v[160:163], v[116:131]
    ds_read_b64_tr_b16 v[164:165], v1 offset:57344
    ds_read_b64_tr_b16 v[166:167], v1 offset:57856
    s_cmp_eq_u32 s5, 15
    s_cbranch_scc1 KF_EPI_GATE
KF_P2:
    s_waitcnt lgkmcnt(6)
    v_mfma_f32_32x32x16_bf16 v[132:147], v[148:151], v[20:23], 0
    ds_read_b64_tr_b16 v[10:11], v18 offset:53248
    ds_read_b64_tr_b16 v[12:13], v18 offset:53760
    ds_read_b64_tr_b16 v[14:15], v18 offset:49152
    ds_read_b64_tr_b16 v[16:17], v18 offset:49664
    ds_read_b64_tr_b16 v[160:161], v1 offset:53248
    ds_read_b64_tr_b16 v[162:163], v1 offset:53760
    v_pk_mul_f32 v[100:101], v[100:101], s[68:69]
    v_pk_mul_f32 v[102:103], v[102:103], s[68:69]
    v_pk_mul_f32 v[104:105], v[104:105], s[68:69]
    v_pk_mul_f32 v[106:107], v[106:107], s[68:69]
    v_cvt_pk_bf16_f32 v100, v100, v101
    v_cvt_pk_bf16_f32 v101, v102, v103
    v_cvt_pk_bf16_f32 v102, v104, v105
    v_cvt_pk_bf16_f32 v103, v106, v107
    s_cmp_lg_u32 s10, 0
    s_cbranch_scc1 KF_S00
    buffer_store_dwordx4 v[100:103], v2, s[36:39], s16 offen sc1
KF_S00:
    v_pk_mul_f32 v[108:109], v[108:109], s[68:69]
    v_pk_mul_f32 v[110:111], v[110:111], s[68:69]
    v_pk_mul_f32 v[112:113], v[112:113], s[68:69]
    v_pk_mul_f32 v[114:115], v[114:115], s[68:69]
    v_cvt_pk_bf16_f32 v104, v108, v109
    v_cvt_pk_bf16_f32 v105, v110, v111
    v_cvt_pk_bf16_f32 v106, v112, v113
    v_cvt_pk_bf16_f32 v107, v114, v115
    s_cmp_lg_u32 s10, 0
    s_cbranch_scc1 KF_S01
    buffer_store_dwordx4 v[104:107], v2, s[36:39], s17 offen sc1
KF_S01:
    s_waitcnt lgkmcnt(10)
    v_mfma_f32_32x32x16_bf16 v[132:147], v[152:155], v[24:27], v[132:147]
    ds_read_b64_tr_b16 v[148:149], v1 offset:49152
    ds_read_b64_tr_b16 v[150:151], v1 offset:49664
    v_pk_mul_f32 v[116:117], v[116:117], s[68:69]
    v_pk_mul_f32 v[118:119], v[118:119], s[68:69]
    v_pk_mul_f32 v[120:121], v[120:121], s[68:69]
    v_pk_mul_f32 v[122:123], v[122:123], s[68:69]
    v_cvt_pk_bf16_f32 v108, v116, v117
    v_cvt_pk_bf16_f32 v109, v118, v119
    v_cvt_pk_bf16_f32 v110, v120, v121
    v_cvt_pk_bf16_f32 v111, v122, v123
    s_cmp_lg_u32 s10, 0
    s_cbranch_scc1 KF_S02
    buffer_store_dwordx4 v[108:111], v2, s[36:39], s18 offen sc1
KF_S02:
    v_pk_mul_f32 v[124:125], v[124:125], s[68:69]
    v_pk_mul_f32 v[126:127], v[126:127], s[68:69]
    v_pk_mul_f32 v[128:129], v[128:129], s[68:69]
    v_pk_mul_f32 v[130:131], v[130:131], s[68:69]
    v_cvt_pk_bf16_f32 v112, v124, v125
    v_cvt_pk_bf16_f32 v113, v126, v127
    v_cvt_pk_bf16_f32 v114, v128, v129
    v_cvt_pk_bf16_f32 v115, v130, v131
    s_cmp_lg_u32 s10, 0
    s_cbranch_scc1 KF_S03
    s_cmp_eq_u32 s22, 1
    s_cbranch_scc1 KF_SQ03_V
    buffer_store_dwordx2 v[112:113], v19, s[36:39], s19 offen sc1
    buffer_store_dwordx2 v[114:115], v9, s[36:39], s20 offen sc1
    s_branch KF_SQ03_E
KF_SQ03_V:
    buffer_store_dwordx4 v[112:115], v2, s[36:39], s19 offen sc1
KF_SQ03_E:
KF_S03:
    s_waitcnt lgkmcnt(10)
    v_mfma_f32_32x32x16_bf16 v[116:131], v[156:159], v[20:23], 0
    s_barrier
    ds_read_b64_tr_b16 v[152:153], v18 offset:45056
    ds_read_b64_tr_b16 v[154:155], v18 offset:45568
    s_waitcnt lgkmcnt(10)
    v_mfma_f32_32x32x16_bf16 v[116:131], v[164:167], v[24:27], v[116:131]
    ds_read_b64_tr_b16 v[156:157], v18 offset:40960
    ds_read_b64_tr_b16 v[158:159], v18 offset:41472
    s_waitcnt lgkmcnt(10)
    v_mfma_f32_32x32x16_bf16 v[132:147], v[10:13], v[28:31], v[132:147]
    ds_read_b64_tr_b16 v[164:165], v1 offset:45056
    ds_read_b64_tr_b16 v[166:167], v1 offset:45568
    s_waitcnt lgkmcnt(10)
    v_mfma_f32_32x32x16_bf16 v[132:147], v[14:17], v[32:35], v[132:147]
    ds_read_b64_tr_b16 v[10:11], v1 offset:40960
    ds_read_b64_tr_b16 v[12:13], v1 offset:41472
    s_waitcnt lgkmcnt(10)
    v_mfma_f32_32x32x16_bf16 v[116:131], v[160:163], v[28:31], v[116:131]
    ds_read_b64_tr_b16 v[14:15], v18 offset:36864
    ds_read_b64_tr_b16 v[16:17], v18 offset:37376
    s_waitcnt lgkmcnt(10)
    v_mfma_f32_32x32x16_bf16 v[116:131], v[148:151], v[32:35], v[116:131]
    ds_read_b64_tr_b16 v[160:161], v18 offset:32768
    ds_read_b64_tr_b16 v[162:163], v18 offset:33280
    s_waitcnt lgkmcnt(10)
    v_mfma_f32_32x32x16_bf16 v[132:147], v[152:155], v[36:39], v[132:147]
    ds_read_b64_tr_b16 v[148:149], v1 offset:36864
    ds_read_b64_tr_b16 v[150:151], v1 offset:37376
    s_getreg_b32 s13, hwreg(HW_REG_IB_STS, 0, 4)
    s_add_u32 s13, s13, s21
    s_cmp_gt_u32 s13, 0
    s_cbranch_scc1 KF_ACKB8
    s_waitcnt vmcnt(0)
    s_call_b64 s[26:27], KF_ACK
KF_ACKB8:
    s_waitcnt lgkmcnt(10)
    v_mfma_f32_32x32x16_bf16 v[132:147], v[156:159], v[40:43], v[132:147]
    ds_read_b64_tr_b16 v[152:153], v1 offset:32768
    ds_read_b64_tr_b16 v[154:155], v1 offset:33280
    s_waitcnt lgkmcnt(10)
    v_mfma_f32_32x32x16_bf16 v[116:131], v[164:167], v[36:39], v[116:131]
    ds_read_b64_tr_b16 v[156:157], v18 offset:28672
    ds_read_b64_tr_b16 v[158:159], v18 offset:29184
    s_getreg_b32 s13, hwreg(HW_REG_IB_STS, 0, 4)
    s_add_u32 s13, s13, s21
    s_cmp_gt_u32 s13, 0
    s_cbranch_scc1 KF_ACKB10
    s_waitcnt vmcnt(0)
    s_call_b64 s[26:27], KF_ACK
KF_ACKB10:
    s_waitcnt lgkmcnt(10)
    v_mfma_f32_32x32x16_bf16 v[116:131], v[10:13], v[40:43], v[116:131]
    ds_read_b64_tr_b16 v[164:165], v18 offset:24576
    ds_read_b64_tr_b16 v[166:167], v18 offset:25088
    s_waitcnt lgkmcnt(10)
    v_mfma_f32_32x32x16_bf16 v[132:147], v[14:17], v[44:47], v[132:147]
    s_barrier
    ds_read_b64_tr_b16 v[10:11], v18 offset:20480
    ds_read_b64_tr_b16 v[12:13], v18 offset:20992
    s_getreg_b32 s13, hwreg(HW_REG_IB_STS, 0, 4)
    s_add_u32 s13, s13, s21
    s_cmp_gt_u32 s13, 0
    s_cbranch_scc1 KF_ACKB12
    s_waitcnt vmcnt(0)
    s_call_b64 s[26:27], KF_ACK
KF_ACKB12:
    s_waitcnt lgkmcnt(10)
    v_mfma_f32_32x32x16_bf16 v[132:147], v[160:163], v[48:51], v[132:147]
    ds_read_b64_tr_b16 v[14:15], v18 offset:16384
    ds_read_b64_tr_b16 v[16:17], v18 offset:16896
    s_waitcnt lgkmcnt(10)
    v_mfma_f32_32x32x16_bf16 v[116:131], v[148:151], v[44:47], v[116:131]
    ds_read_b64_tr_b16 v[160:161], v18 offset:12288
    ds_read_b64_tr_b16 v[162:163], v18 offset:12800
    s_cmp_lg_u32 s10, 1
    s_cbranch_scc1 KF_S10
    buffer_store_dwordx4 v[100:103], v2, s[36:39], s16 offen sc1
KF_S10:
    s_getreg_b32 s13, hwreg(HW_REG_IB_STS, 0, 4)
    s_add_u32 s13, s13, s21
    s_cmp_gt_u32 s13, 0
    s_cbranch_scc1 KF_ACKB14
    s_waitcnt vmcnt(0)
    s_call_b64 s[26:27], KF_ACK
KF_ACKB14:
    s_waitcnt lgkmcnt(10)
    v_mfma_f32_32x32x16_bf16 v[116:131], v[152:155], v[48:51], v[116:131]
    ds_read_b64_tr_b16 v[148:149], v18 offset:8192
    ds_read_b64_tr_b16 v[150:151], v18 offset:8704
    s_waitcnt lgkmcnt(10)
    v_mfma_f32_32x32x16_bf16 v[132:147], v[156:159], v[52:55], v[132:147]
    ds_read_b64_tr_b16 v[152:153], v18 offset:4096
    ds_read_b64_tr_b16 v[154:155], v18 offset:4608
    s_cmp_lg_u32 s10, 1
    s_cbranch_scc1 KF_S11
    buffer_store_dwordx4 v[104:107], v2, s[36:39], s17 offen sc1
KF_S11:
    s_getreg_b32 s13, hwreg(HW_REG_IB_STS, 0, 4)
    s_add_u32 s13, s13, s21
    s_cmp_gt_u32 s13, 0
    s_cbranch_scc1 KF_ACKB16
    s_waitcnt vmcnt(0)
    s_call_b64 s[26:27], KF_ACK
KF_ACKB16:
    s_waitcnt lgkmcnt(10)
    v_mfma_f32_32x32x16_bf16 v[132:147], v[164:167], v[56:59], v[132:147]
    ds_read_b64_tr_b16 v[156:157], v18 offset:0
    ds_read_b64_tr_b16 v[158:159], v18 offset:512
    s_waitcnt lgkmcnt(10)
    v_mfma_f32_32x32x16_bf16 v[132:147], v[10:13], v[60:63], v[132:147]
    v_add_u32 v18, 0xffff1000, v18
    ds_read_b64_tr_b16 v[164:165], v18 offset:57344
    ds_read_b64_tr_b16 v[166:167], v18 offset:57856
    s_cmp_lg_u32 s10, 1
    s_cbranch_scc1 KF_S12
    buffer_store_dwordx4 v[108:111], v2, s[36:39], s18 offen sc1
KF_S12:
    s_getreg_b32 s13, hwreg(HW_REG_IB_STS, 0, 4)
    s_add_u32 s13, s13, s21
    s_cmp_gt_u32 s13, 0
    s_cbranch_scc1 KF_ACKB18
    s_waitcnt vmcnt(0)
    s_call_b64 s[26:27], KF_ACK
KF_ACKB18:
    s_waitcnt lgkmcnt(10)
    v_mfma_f32_32x32x16_bf16 v[132:147], v[14:17], v[64:67], v[132:147]
    s_barrier
    ds_read_b64_tr_b16 v[10:11], v18 offset:53248
    ds_read_b64_tr_b16 v[12:13], v18 offset:53760
    s_waitcnt lgkmcnt(10)
    v_mfma_f32_32x32x16_bf16 v[132:147], v[160:163], v[68:71], v[132:147]
    ds_read_b64_tr_b16 v[14:15], v18 offset:49152
    ds_read_b64_tr_b16 v[16:17], v18 offset:49664
    s_cmp_lg_u32 s10, 1
    s_cbranch_scc1 KF_S13
    s_cmp_eq_u32 s22, 1
    s_cbranch_scc1 KF_SQ13_V
    buffer_store_dwordx2 v[112:113], v19, s[36:39], s19 offen sc1
    buffer_store_dwordx2 v[114:115], v9, s[36:39], s20 offen sc1
    s_branch KF_SQ13_E
KF_SQ13_V:
    buffer_store_dwordx4 v[112:115], v2, s[36:39], s19 offen sc1
KF_SQ13_E:
    s_mov_b32 s21, 0
KF_S13:
    s_getreg_b32 s13, hwreg(HW_REG_IB_STS, 0, 4)
    s_add_u32 s13, s13, s21
    s_cmp_gt_u32 s13, 0
    s_cbranch_scc1 KF_ACKB20
    s_waitcnt vmcnt(0)
    s_call_b64 s[26:27], KF_ACK
KF_ACKB20:
    s_waitcnt lgkmcnt(10)
    v_mfma_f32_32x32x16_bf16 v[132:147], v[148:151], v[72:75], v[132:147]
    ds_read_b64_tr_b16 v[160:161], v18 offset:45056
    ds_read_b64_tr_b16 v[162:163], v18 offset:45568
    s_waitcnt lgkmcnt(10)
    v_mfma_f32_32x32x16_bf16 v[132:147], v[152:155], v[76:79], v[132:147]
    ds_read_b64_tr_b16 v[148:149], v1 offset:28672
    ds_read_b64_tr_b16 v[150:151], v1 offset:29184
    s_getreg_b32 s13, hwreg(HW_REG_IB_STS, 0, 4)
    s_add_u32 s13, s13, s21
    s_cmp_gt_u32 s13, 0
    s_cbranch_scc1 KF_ACKB22
    s_waitcnt vmcnt(0)
    s_call_b64 s[26:27], KF_ACK
KF_ACKB22:
    s_waitcnt lgkmcnt(10)
    v_mfma_f32_32x32x16_bf16 v[132:147], v[156:159], v[80:83], v[132:147]
    ds_read_b64_tr_b16 v[152:153], v1 offset:24576
    ds_read_b64_tr_b16 v[154:155], v1 offset:25088
    s_waitcnt lgkmcnt(10)
    v_mfma_f32_32x32x16_bf16 v[132:147], v[164:167], v[84:87], v[132:147]
    ds_read_b64_tr_b16 v[156:157], v1 offset:20480
    ds_read_b64_tr_b16 v[158:159], v1 offset:20992
    s_getreg_b32 s13, hwreg(HW_REG_IB_STS, 0, 4)
    s_add_u32 s13, s13, s21
    s_cmp_gt_u32 s13, 0
    s_cbranch_scc1 KF_ACKB24
    s_waitcnt vmcnt(0)
    s_call_b64 s[26:27], KF_ACK
KF_ACKB24:
    s_waitcnt lgkmcnt(10)
    v_mfma_f32_32x32x16_bf16 v[132:147], v[10:13], v[88:91], v[132:147]
    ds_read_b64_tr_b16 v[164:165], v1 offset:16384
    ds_read_b64_tr_b16 v[166:167], v1 offset:16896
    s_waitcnt lgkmcnt(10)
    v_mfma_f32_32x32x16_bf16 v[132:147], v[14:17], v[92:95], v[132:147]
    ds_read_b64_tr_b16 v[10:11], v1 offset:12288
    ds_read_b64_tr_b16 v[12:13], v1 offset:12800
    s_getreg_b32 s13, hwreg(HW_REG_IB_STS, 0, 4)
    s_add_u32 s13, s13, s21
    s_cmp_gt_u32 s13, 0
    s_cbranch_scc1 KF_ACKB26
    s_waitcnt vmcnt(0)
    s_call_b64 s[26:27], KF_ACK
KF_ACKB26:
    s_waitcnt lgkmcnt(10)
    v_mfma_f32_32x32x16_bf16 v[132:147], v[160:163], v[96:99], v[132:147]
    ds_read_b64_tr_b16 v[14:15], v1 offset:8192
    ds_read_b64_tr_b16 v[16:17], v1 offset:8704
    s_waitcnt lgkmcnt(10)
    v_mfma_f32_32x32x16_bf16 v[116:131], v[148:151], v[52:55], v[116:131]
    ds_read_b64_tr_b16 v[160:161], v1 offset:4096
    ds_read_b64_tr_b16 v[162:163], v1 offset:4608
    s_getreg_b32 s13, hwreg(HW_REG_IB_STS, 0, 4)
    s_add_u32 s13, s13, s21
    s_cmp_gt_u32 s13, 0
    s_cbranch_scc1 KF_ACKB28
    s_waitcnt vmcnt(0)
    s_call_b64 s[26:27], KF_ACK
KF_ACKB28:
    s_waitcnt lgkmcnt(10)
    v_mfma_f32_32x32x16_bf16 v[116:131], v[152:155], v[56:59], v[116:131]
    ds_read_b64_tr_b16 v[148:149], v1 offset:0
    ds_read_b64_tr_b16 v[150:151], v1 offset:512
    s_add_u32 s13, s11, 131072
    v_add_u32 v8, s13, v2
    ds_write_b128 v8, v[140:143] offset:0
    ds_write_b128 v8, v[144:147] offset:1024
    s_waitcnt lgkmcnt(12)
    v_mfma_f32_32x32x16_bf16 v[116:131], v[156:159], v[60:63], v[116:131]
    s_waitcnt lgkmcnt(0)
    s_barrier
    v_add_u32 v1, 0xffff1000, v1
    ds_read_b64_tr_b16 v[152:153], v1 offset:57344
    ds_read_b64_tr_b16 v[154:155], v1 offset:57856
    s_xor_b32 s13, s11, 8192
    s_add_u32 s13, s13, 131072
    v_add_u32 v8, s13, v2
    ds_read_b128 v[140:143], v8 offset:0
    ds_read_b128 v[144:147], v8 offset:1024
    s_getreg_b32 s13, hwreg(HW_REG_IB_STS, 0, 4)
    s_add_u32 s13, s13, s21
    s_cmp_gt_u32 s13, 0
    s_cbranch_scc1 KF_ACKB30
    s_waitcnt vmcnt(0)
    s_call_b64 s[26:27], KF_ACK
KF_ACKB30:
    v_mfma_f32_32x32x16_bf16 v[116:131], v[164:167], v[64:67], v[116:131]
    ds_read_b64_tr_b16 v[156:157], v1 offset:53248
    ds_read_b64_tr_b16 v[158:159], v1 offset:53760
    v_mfma_f32_32x32x16_bf16 v[116:131], v[10:13], v[68:71], v[116:131]
    ds_read_b64_tr_b16 v[164:165], v1 offset:49152
    ds_read_b64_tr_b16 v[166:167], v1 offset:49664
    s_waitcnt lgkmcnt(4)
    v_pk_add_f32 v[132:133], v[132:133], v[140:141]
    v_pk_add_f32 v[134:135], v[134:135], v[142:143]
    v_pk_add_f32 v[136:137], v[136:137], v[144:145]
    v_pk_add_f32 v[138:139], v[138:139], v[146:147]
    v_pk_mul_f32 v[140:141], v[132:133], s[64:65]
    v_pk_mul_f32 v[142:143], v[134:135], s[64:65]
    v_pk_mul_f32 v[144:145], v[136:137], s[64:65]
    v_pk_mul_f32 v[146:147], v[138:139], s[64:65]
    s_getreg_b32 s13, hwreg(HW_REG_IB_STS, 0, 4)
    s_add_u32 s13, s13, s21
    s_cmp_gt_u32 s13, 0
    s_cbranch_scc1 KF_ACKB32
    s_waitcnt vmcnt(0)
    s_call_b64 s[26:27], KF_ACK
KF_ACKB32:
    v_mfma_f32_32x32x16_bf16 v[116:131], v[14:17], v[72:75], v[116:131]
    ds_read_b64_tr_b16 v[10:11], v1 offset:45056
    ds_read_b64_tr_b16 v[12:13], v1 offset:45568
    v_exp_f32 v140, v140
    v_exp_f32 v141, v141
    v_exp_f32 v142, v142
    v_exp_f32 v143, v143
    v_mfma_f32_32x32x16_bf16 v[116:131], v[160:163], v[76:79], v[116:131]
    ds_read_b64_tr_b16 v[14:15], v18 offset:40960
    ds_read_b64_tr_b16 v[16:17], v18 offset:41472
    v_exp_f32 v144, v144
    v_exp_f32 v145, v145
    v_exp_f32 v146, v146
    v_exp_f32 v147, v147
    s_getreg_b32 s13, hwreg(HW_REG_IB_STS, 0, 4)
    s_add_u32 s13, s13, s21
    s_cmp_gt_u32 s13, 0
    s_cbranch_scc1 KF_ACKB34
    s_waitcnt vmcnt(0)
    s_call_b64 s[26:27], KF_ACK
KF_ACKB34:
    v_mfma_f32_32x32x16_bf16 v[116:131], v[148:151], v[80:83], v[116:131]
    ds_read_b64_tr_b16 v[160:161], v1 offset:40960
    ds_read_b64_tr_b16 v[162:163], v1 offset:41472
    v_pk_add_f32 v[140:141], v[140:141], s[66:67]
    v_pk_add_f32 v[142:143], v[142:143], s[66:67]
    v_pk_add_f32 v[144:145], v[144:145], s[66:67]
    v_pk_add_f32 v[146:147], v[146:147], s[66:67]
    v_mfma_f32_32x32x16_bf16 v[116:131], v[152:155], v[84:87], v[116:131]
    ds_read_b64_tr_b16 v[148:149], v18 offset:36864
    ds_read_b64_tr_b16 v[150:151], v18 offset:37376
    v_rcp_f32 v140, v140
    v_rcp_f32 v141, v141
    v_rcp_f32 v142, v142
    v_rcp_f32 v143, v143
    s_getreg_b32 s13, hwreg(HW_REG_IB_STS, 0, 4)
    s_add_u32 s13, s13, s21
    s_cmp_gt_u32 s13, 0
    s_cbranch_scc1 KF_ACKB36
    s_waitcnt vmcnt(0)
    s_call_b64 s[26:27], KF_ACK
KF_ACKB36:
    s_waitcnt lgkmcnt(10)
    v_mfma_f32_32x32x16_bf16 v[116:131], v[156:159], v[88:91], v[116:131]
    ds_read_b64_tr_b16 v[152:153], v1 offset:36864
    ds_read_b64_tr_b16 v[154:155], v1 offset:37376
    v_rcp_f32 v144, v144
    v_rcp_f32 v145, v145
    v_rcp_f32 v146, v146
    v_rcp_f32 v147, v147
    s_waitcnt lgkmcnt(10)
    v_mfma_f32_32x32x16_bf16 v[116:131], v[164:167], v[92:95], v[116:131]
    ds_read_b64_tr_b16 v[156:157], v18 offset:32768
    ds_read_b64_tr_b16 v[158:159], v18 offset:33280
    v_pk_mul_f32 v[140:141], v[132:133], v[140:141]
    v_pk_mul_f32 v[142:143], v[134:135], v[142:143]
    v_pk_mul_f32 v[144:145], v[136:137], v[144:145]
    v_pk_mul_f32 v[146:147], v[138:139], v[146:147]
    v_cvt_pk_bf16_f32 v132, v140, v141
    v_cvt_pk_bf16_f32 v133, v142, v143
    v_cvt_pk_bf16_f32 v134, v144, v145
    v_cvt_pk_bf16_f32 v135, v146, v147
    buffer_store_dwordx4 v[132:135], v2, s[36:39], s12 offen offset:0 sc1
    s_getreg_b32 s13, hwreg(HW_REG_IB_STS, 0, 4)
    s_add_u32 s13, s13, s21
    s_cmp_gt_u32 s13, 1
    s_cbranch_scc1 KF_ACKB38
    s_waitcnt vmcnt(1)
    s_call_b64 s[26:27], KF_ACK
KF_ACKB38:
    s_waitcnt lgkmcnt(10)
    v_mfma_f32_32x32x16_bf16 v[116:131], v[10:13], v[96:99], v[116:131]
    ds_read_b64_tr_b16 v[164:165], v1 offset:32768
    ds_read_b64_tr_b16 v[166:167], v1 offset:33280
    s_waitcnt lgkmcnt(10)
    v_mfma_f32_32x32x16_bf16 v[132:147], v[14:17], v[20:23], 0
    ds_read_b64_tr_b16 v[10:11], v18 offset:28672
    ds_read_b64_tr_b16 v[12:13], v18 offset:29184
    s_getreg_b32 s13, hwreg(HW_REG_IB_STS, 0, 4)
    s_add_u32 s13, s13, s21
    s_cmp_gt_u32 s13, 1
    s_cbranch_scc1 KF_ACKB40
    s_waitcnt vmcnt(1)
    s_call_b64 s[26:27], KF_ACK
KF_ACKB40:
    s_waitcnt lgkmcnt(10)
    v_mfma_f32_32x32x16_bf16 v[132:147], v[160:163], v[24:27], v[132:147]
    ds_read_b64_tr_b16 v[14:15], v1 offset:28672
    ds_read_b64_tr_b16 v[16:17], v1 offset:29184
    s_add_u32 s13, s11, 147456
    v_add_u32 v8, s13, v2
    ds_write_b128 v8, v[124:127] offset:0
    ds_write_b128 v8, v[128:131] offset:1024
    s_waitcnt lgkmcnt(12)
    v_mfma_f32_32x32x16_bf16 v[132:147], v[148:151], v[28:31], v[132:147]
    ds_read_b64_tr_b16 v[160:161], v18 offset:20480
    ds_read_b64_tr_b16 v[162:163], v18 offset:20992
    s_getreg_b32 s13, hwreg(HW_REG_IB_STS, 0, 4)
    s_add_u32 s13, s13, s21
    s_cmp_gt_u32 s13, 1
    s_cbranch_scc1 KF_ACKB42
    s_waitcnt vmcnt(1)
    s_call_b64 s[26:27], KF_ACK
KF_ACKB42:
    s_waitcnt lgkmcnt(12)
    v_mfma_f32_32x32x16_bf16 v[132:147], v[152:155], v[32:35], v[132:147]
    ds_read_b64_tr_b16 v[148:149], v1 offset:20480
    ds_read_b64_tr_b16 v[150:151], v1 offset:20992
    s_waitcnt lgkmcnt(12)
    v_mfma_f32_32x32x16_bf16 v[132:147], v[156:159], v[36:39], v[132:147]
    s_waitcnt lgkmcnt(4)
    s_barrier
    ds_read_b64_tr_b16 v[152:153], v18 offset:16384
    ds_read_b64_tr_b16 v[154:155], v18 offset:16896
    s_xor_b32 s13, s11, 8192
    s_add_u32 s13, s13, 147456
    v_add_u32 v8, s13, v2
    ds_read_b128 v[124:127], v8 offset:0
    ds_read_b128 v[128:131], v8 offset:1024
    s_getreg_b32 s13, hwreg(HW_REG_IB_STS, 0, 4)
    s_add_u32 s13, s13, s21
    s_cmp_gt_u32 s13, 1
    s_cbranch_scc1 KF_ACKB44
    s_waitcnt vmcnt(1)
    s_call_b64 s[26:27], KF_ACK
KF_ACKB44:
    v_mfma_f32_32x32x16_bf16 v[132:147], v[164:167], v[40:43], v[132:147]
    ds_read_b64_tr_b16 v[156:157], v1 offset:16384
    ds_read_b64_tr_b16 v[158:159], v1 offset:16896
    v_mfma_f32_32x32x16_bf16 v[132:147], v[10:13], v[44:47], v[132:147]
    ds_read_b64_tr_b16 v[164:165], v18 offset:12288
    ds_read_b64_tr_b16 v[166:167], v18 offset:12800
    s_waitcnt lgkmcnt(4)
    v_pk_add_f32 v[116:117], v[116:117], v[124:125]
    v_pk_add_f32 v[118:119], v[118:119], v[126:127]
    v_pk_add_f32 v[120:121], v[120:121], v[128:129]
    v_pk_add_f32 v[122:123], v[122:123], v[130:131]
    v_pk_mul_f32 v[124:125], v[116:117], s[64:65]
    v_pk_mul_f32 v[126:127], v[118:119], s[64:65]
    v_pk_mul_f32 v[128:129], v[120:121], s[64:65]
    v_pk_mul_f32 v[130:131], v[122:123], s[64:65]
    s_getreg_b32 s13, hwreg(HW_REG_IB_STS, 0, 4)
    s_add_u32 s13, s13, s21
    s_cmp_gt_u32 s13, 1
    s_cbranch_scc1 KF_ACKB46
    s_waitcnt vmcnt(1)
    s_call_b64 s[26:27], KF_ACK
KF_ACKB46:
    v_mfma_f32_32x32x16_bf16 v[132:147], v[14:17], v[48:51], v[132:147]
    ds_read_b64_tr_b16 v[10:11], v1 offset:12288
    ds_read_b64_tr_b16 v[12:13], v1 offset:12800
    v_exp_f32 v124, v124
    v_exp_f32 v125, v125
    v_exp_f32 v126, v126
    v_exp_f32 v127, v127
    v_mfma_f32_32x32x16_bf16 v[132:147], v[160:163], v[52:55], v[132:147]
    ds_read_b64_tr_b16 v[14:15], v18 offset:8192
    ds_read_b64_tr_b16 v[16:17], v18 offset:8704
    v_exp_f32 v128, v128
    v_exp_f32 v129, v129
    v_exp_f32 v130, v130
    v_exp_f32 v131, v131
    s_and_b32 s4, s2, 7
    s_lshl_b32 s4, s4, 2
    s_bfe_u32 s5, s2, 0x20003
    s_add_u32 s4, s4, s5
    s_mul_i32 s6, s4, 1280
    s_add_u32 s6, s6, 0x300000
    v_cmp_gt_u32 s[14:15], 32, v0
    v_lshlrev_b32 v32, 3, v3
    v_mov_b32 v33, 0x40000
    v_mov_b32 v20, v2
    s_getreg_b32 s13, hwreg(HW_REG_IB_STS, 0, 4)
    s_add_u32 s13, s13, s21
    s_cmp_gt_u32 s13, 1
    s_cbranch_scc1 KF_ACKB48
    s_waitcnt vmcnt(1)
    s_call_b64 s[26:27], KF_ACK
KF_ACKB48:
    v_mfma_f32_32x32x16_bf16 v[132:147], v[148:151], v[56:59], v[132:147]
    ds_read_b64_tr_b16 v[160:161], v1 offset:8192
    ds_read_b64_tr_b16 v[162:163], v1 offset:8704
    v_pk_add_f32 v[124:125], v[124:125], s[66:67]
    v_pk_add_f32 v[126:127], v[126:127], s[66:67]
    v_pk_add_f32 v[128:129], v[128:129], s[66:67]
    v_pk_add_f32 v[130:131], v[130:131], s[66:67]
    s_lshr_b32 s5, s2, 5
    s_lshl_b32 s5, s5, 3
    s_add_u32 s5, s5, s3
    s_mul_i32 s7, s3, 1280
    s_add_u32 s7, s7, 20992
    v_add_u32 v24, s7, v2
    v_add_u32 v25, s7, v32
    v_cndmask_b32 v25, v33, v25, s[14:15]
    v_add_u32 v32, 1024, v32
    v_mfma_f32_32x32x16_bf16 v[132:147], v[152:155], v[60:63], v[132:147]
    ds_read_b64_tr_b16 v[148:149], v18 offset:4096
    ds_read_b64_tr_b16 v[150:151], v18 offset:4608
    v_rcp_f32 v124, v124
    v_rcp_f32 v125, v125
    v_rcp_f32 v126, v126
    v_rcp_f32 v127, v127
    s_lshl_b32 s8, s3, 7
    s_add_u32 s8, s8, 31232
    v_lshl_add_u32 v26, v3, 2, s8
    v_mov_b32 v34, 1600
    v_cndmask_b32 v21, v34, v32, s[14:15]
    s_getreg_b32 s13, hwreg(HW_REG_IB_STS, 0, 4)
    s_add_u32 s13, s13, s21
    s_cmp_gt_u32 s13, 1
    s_cbranch_scc1 KF_ACKB50
    s_waitcnt vmcnt(1)
    s_call_b64 s[26:27], KF_ACK
KF_ACKB50:
    s_waitcnt lgkmcnt(10)
    v_mfma_f32_32x32x16_bf16 v[132:147], v[156:159], v[64:67], v[132:147]
    ds_read_b64_tr_b16 v[152:153], v1 offset:4096
    ds_read_b64_tr_b16 v[154:155], v1 offset:4608
    v_rcp_f32 v128, v128
    v_rcp_f32 v129, v129
    v_rcp_f32 v130, v130
    v_rcp_f32 v131, v131
    v_cmp_lt_u32 vcc, 20, v3
    v_mul_u32_u24 v34, 336, v4
    v_lshl_add_u32 v34, v3, 4, v34
    v_cndmask_b32 v34, v34, v33, vcc
    s_waitcnt lgkmcnt(10)
    v_mfma_f32_32x32x16_bf16 v[132:147], v[164:167], v[68:71], v[132:147]
    ds_read_b64_tr_b16 v[156:157], v18 offset:0
    ds_read_b64_tr_b16 v[158:159], v18 offset:512
    v_pk_mul_f32 v[124:125], v[116:117], v[124:125]
    v_pk_mul_f32 v[126:127], v[118:119], v[126:127]
    v_pk_mul_f32 v[128:129], v[120:121], v[128:129]
    v_pk_mul_f32 v[130:131], v[122:123], v[130:131]
    v_cvt_pk_bf16_f32 v116, v124, v125
    v_cvt_pk_bf16_f32 v117, v126, v127
    v_cvt_pk_bf16_f32 v118, v128, v129
    v_cvt_pk_bf16_f32 v119, v130, v131
    buffer_store_dwordx4 v[116:119], v2, s[36:39], s12 offen offset:2048 sc1
    v_add_u32 v22, 1280, v34
    v_add_u32 v23, 1952, v34
    s_getreg_b32 s13, hwreg(HW_REG_IB_STS, 0, 4)
    s_add_u32 s13, s13, s21
    s_cmp_gt_u32 s13, 2
    s_cbranch_scc1 KF_ACKB52
    s_waitcnt vmcnt(2)
    s_call_b64 s[26:27], KF_ACK
KF_ACKB52:
    s_waitcnt lgkmcnt(10)
    v_mfma_f32_32x32x16_bf16 v[132:147], v[10:13], v[72:75], v[132:147]
    ds_read_b64_tr_b16 v[164:165], v1 offset:0
    ds_read_b64_tr_b16 v[166:167], v1 offset:512
    v_mov_b32 v28, 0
    v_mov_b32 v29, 0
    v_mov_b32 v30, 0
    v_mov_b32 v31, 0
    s_waitcnt lgkmcnt(10)
    v_mfma_f32_32x32x16_bf16 v[132:147], v[14:17], v[76:79], v[132:147]
    v_mov_b32 v32, 0
    v_mov_b32 v33, 0
    v_mov_b32 v34, 0
    v_mov_b32 v35, 0
    s_getreg_b32 s13, hwreg(HW_REG_IB_STS, 0, 4)
    s_add_u32 s13, s13, s21
    s_cmp_gt_u32 s13, 2
    s_cbranch_scc1 KF_ACKB54
    s_waitcnt vmcnt(2)
    s_call_b64 s[26:27], KF_ACK
KF_ACKB54:
    s_waitcnt lgkmcnt(8)
    v_mfma_f32_32x32x16_bf16 v[132:147], v[160:163], v[80:83], v[132:147]
    v_mov_b32 v36, 0
    v_mov_b32 v37, 0
    v_mov_b32 v38, 0
    v_mov_b32 v39, 0
    s_waitcnt lgkmcnt(6)
    v_mfma_f32_32x32x16_bf16 v[132:147], v[148:151], v[84:87], v[132:147]
    v_mov_b32 v40, 0
    v_mov_b32 v41, 0
    v_mov_b32 v42, 0
    v_mov_b32 v43, 0
    s_getreg_b32 s13, hwreg(HW_REG_IB_STS, 0, 4)
    s_add_u32 s13, s13, s21
    s_cmp_gt_u32 s13, 2
    s_cbranch_scc1 KF_ACKB56
    s_waitcnt vmcnt(2)
    s_call_b64 s[26:27], KF_ACK
KF_ACKB56:
    s_waitcnt lgkmcnt(4)
    v_mfma_f32_32x32x16_bf16 v[132:147], v[152:155], v[88:91], v[132:147]
    v_mov_b32 v44, 0
    v_mov_b32 v45, 0
    v_mov_b32 v46, 0
    v_mov_b32 v47, 0
    s_waitcnt lgkmcnt(2)
    v_mfma_f32_32x32x16_bf16 v[132:147], v[156:159], v[92:95], v[132:147]
    v_mov_b32 v48, 0
    v_mov_b32 v49, 0
    v_mov_b32 v50, 0
    v_mov_b32 v51, 0
    s_cmp_lg_u32 s21, 0
    s_cbranch_scc1 KF_ACKB58
    s_waitcnt vmcnt(2)
    s_call_b64 s[26:27], KF_ACK
KF_ACKB58:
    s_waitcnt lgkmcnt(0)
    v_mfma_f32_32x32x16_bf16 v[132:147], v[164:167], v[96:99], v[132:147]
    s_add_u32 s13, s11, 114688
    v_add_u32 v8, s13, v2
    s_xor_b32 s13, s13, 8192
    v_add_u32 v131, s13, v2
    s_nop 8
    ds_write_b128 v8, v[140:143] offset:0
    ds_write_b128 v8, v[144:147] offset:1024
    s_waitcnt lgkmcnt(0)
    s_barrier
    ds_read_b128 v[12:15], v24
    ds_read_b128 v[88:91], v20
    ds_read_b64 v[16:17], v25 offset:1024
    ds_read_b64 v[96:97], v21
    ds_read_b128 v[140:143], v131
    ds_read_b128 v[144:147], v131 offset:1024
    ds_read_b128 v[92:95], v20 offset:2624
    ds_read_b64 v[98:99], v21 offset:2624
    ds_read_b128 v[116:119], v22
    ds_read_b32 v124, v26
    s_waitcnt lgkmcnt(6)
    v_mfma_f32_32x32x16_bf16 v[72:87], v[88:91], v[12:15], 0
    v_mfma_f32_32x32x8_bf16 v[72:87], v[96:97], v[16:17], v[72:87]
    v_mfma_f32_32x32x16_bf16 v[56:71], v[88:91], v[12:15], 0
    s_waitcnt lgkmcnt(4)
    v_pk_add_f32 v[132:133], v[132:133], v[140:141]
    v_pk_add_f32 v[134:135], v[134:135], v[142:143]
    v_pk_add_f32 v[136:137], v[136:137], v[144:145]
    v_pk_add_f32 v[138:139], v[138:139], v[146:147]
    v_pk_mul_f32 v[140:141], v[132:133], s[64:65]
    v_pk_mul_f32 v[142:143], v[134:135], s[64:65]
    v_pk_mul_f32 v[144:145], v[136:137], s[64:65]
    v_pk_mul_f32 v[146:147], v[138:139], s[64:65]
    v_exp_f32 v140, v140
    v_exp_f32 v141, v141
    v_exp_f32 v142, v142
    v_exp_f32 v143, v143
    v_exp_f32 v144, v144
    v_exp_f32 v145, v145
    v_exp_f32 v146, v146
    v_exp_f32 v147, v147
    v_max3_f32 v6, v72, v73, v74
    v_max3_f32 v7, v75, v76, v77
    v_max3_f32 v6, v6, v78, v79
    v_max3_f32 v7, v7, v80, v81
    v_max3_f32 v6, v6, v82, v83
    v_max3_f32 v7, v7, v84, v85
    v_max3_f32 v6, v6, v86, v87
    v_max_f32 v6, v6, v7
    v_mov_b32 v7, v6
    s_nop 1
    v_permlane32_swap_b32 v6, v7
    s_nop 1
    v_max_f32 v6, v6, v7
    v_xor_b32 v6, 0x80000000, v6
    v_lshrrev_b32 v6, 16, v6
    v_cndmask_b32 v16, v6, v16, s[14:15]
    s_mov_b32 s9, 0
    s_mov_b32 s32, 0xffffae00
    s_mov_b32 s24, 62976
    s_mov_b32 s23, 1
    s_mov_b32 s29, s30
    s_mov_b32 s31, 0xffff
    s_mov_b32 s21, 0
    v_mfma_f32_32x32x8_bf16 v[56:71], v[96:97], v[16:17], v[56:71]
    v_pk_add_f32 v[140:141], v[140:141], s[66:67]
    v_pk_add_f32 v[142:143], v[142:143], s[66:67]
    v_pk_add_f32 v[144:145], v[144:145], s[66:67]
    v_pk_add_f32 v[146:147], v[146:147], s[66:67]
    v_rcp_f32 v140, v140
    v_rcp_f32 v141, v141
    v_rcp_f32 v142, v142
    v_rcp_f32 v143, v143
    v_rcp_f32 v144, v144
    v_rcp_f32 v145, v145
    v_rcp_f32 v146, v146
    v_rcp_f32 v147, v147
    v_pk_mul_f32 v[140:141], v[132:133], v[140:141]
    v_pk_mul_f32 v[142:143], v[134:135], v[142:143]
    v_pk_mul_f32 v[144:145], v[136:137], v[144:145]
    v_pk_mul_f32 v[146:147], v[138:139], v[146:147]
    v_cvt_pk_bf16_f32 v132, v140, v141
    v_cvt_pk_bf16_f32 v133, v142, v143
    v_cvt_pk_bf16_f32 v134, v144, v145
    v_cvt_pk_bf16_f32 v135, v146, v147
    s_add_u32 s12, s12, s28
    buffer_store_dwordx4 v[132:135], v2, s[36:39], s12 offen offset:0 sc1
    s_mov_b32 s12, 2
    s_add_u32 s12, s12, 1
    s_cmp_eq_u32 s12, 3
    s_cselect_b32 s25, 41984, s32
    s_cselect_b32 s12, 0, s12
    s_waitcnt lgkmcnt(0)
    v_mfma_f32_32x32x16_bf16 v[72:87], v[92:95], v[12:15], 0
    ds_read_b128 v[52:55], v23 offset:0
    ds_read_b128 v[88:91], v20 offset:5248
    s_cmp_lg_u32 s10, 2
    s_cbranch_scc1 KF_S20
    buffer_store_dwordx4 v[100:103], v2, s[36:39], s16 offen sc1
KF_S20:
    v_exp_f32 v56, v56
    v_exp_f32 v57, v57
    v_exp_f32 v58, v58
    v_exp_f32 v59, v59
    v_cvt_pk_bf16_f32 v24, v56, v57
    v_cvt_pk_bf16_f32 v25, v58, v59
    v_mfma_f32_32x32x16_bf16 v[32:47], v[48:51], v[28:31], v[32:47]
    ds_read_b128 v[120:123], v22 offset:2624
    ds_read_b64 v[96:97], v21 offset:5248
    v_exp_f32 v60, v60
    v_exp_f32 v61, v61
    v_exp_f32 v62, v62
    v_exp_f32 v63, v63
    v_cvt_pk_bf16_f32 v26, v60, v61
    v_cvt_pk_bf16_f32 v27, v62, v63
    v_mfma_f32_32x32x8_bf16 v[72:87], v[98:99], v[16:17], v[72:87]
    v_exp_f32 v64, v64
    v_exp_f32 v65, v65
    v_exp_f32 v66, v66
    v_exp_f32 v67, v67
    v_cvt_pk_bf16_f32 v28, v64, v65
    v_cvt_pk_bf16_f32 v29, v66, v67
    v_mfma_f32_32x32x16_bf16 v[32:47], v[116:119], v[24:27], v[32:47]
    v_exp_f32 v68, v68
    v_exp_f32 v69, v69
    v_exp_f32 v70, v70
    v_exp_f32 v71, v71
    v_cvt_pk_bf16_f32 v30, v68, v69
    v_cvt_pk_bf16_f32 v31, v70, v71
    s_waitcnt lgkmcnt(0)
    v_mfma_f32_32x32x16_bf16 v[56:71], v[88:91], v[12:15], 0
    ds_read_b128 v[48:51], v23 offset:2624
    ds_read_b128 v[92:95], v20 offset:7872
    s_cmp_lg_u32 s10, 2
    s_cbranch_scc1 KF_S21
    buffer_store_dwordx4 v[104:107], v2, s[36:39], s17 offen sc1
KF_S21:
    v_exp_f32 v72, v72
    v_exp_f32 v73, v73
    v_exp_f32 v74, v74
    v_exp_f32 v75, v75
    v_cvt_pk_bf16_f32 v24, v72, v73
    v_cvt_pk_bf16_f32 v25, v74, v75
    v_mfma_f32_32x32x16_bf16 v[32:47], v[52:55], v[28:31], v[32:47]
    ds_read_b128 v[116:119], v22 offset:5248
    ds_read_b64 v[98:99], v21 offset:7872
    v_exp_f32 v76, v76
    v_exp_f32 v77, v77
    v_exp_f32 v78, v78
    v_exp_f32 v79, v79
    v_cvt_pk_bf16_f32 v26, v76, v77
    v_cvt_pk_bf16_f32 v27, v78, v79
    v_mfma_f32_32x32x8_bf16 v[56:71], v[96:97], v[16:17], v[56:71]
    v_exp_f32 v80, v80
    v_exp_f32 v81, v81
    v_exp_f32 v82, v82
    v_exp_f32 v83, v83
    v_cvt_pk_bf16_f32 v28, v80, v81
    v_cvt_pk_bf16_f32 v29, v82, v83
    v_mfma_f32_32x32x16_bf16 v[32:47], v[120:123], v[24:27], v[32:47]
    v_exp_f32 v84, v84
    v_exp_f32 v85, v85
    v_exp_f32 v86, v86
    v_exp_f32 v87, v87
    v_cvt_pk_bf16_f32 v30, v84, v85
    v_cvt_pk_bf16_f32 v31, v86, v87
    s_setprio 1
    s_waitcnt lgkmcnt(0)
    v_mfma_f32_32x32x16_bf16 v[72:87], v[92:95], v[12:15], 0
    ds_read_b128 v[52:55], v23 offset:5248
    ds_read_b128 v[88:91], v20 offset:10496
    s_cmp_lg_u32 s10, 2
    s_cbranch_scc1 KF_S22
    buffer_store_dwordx4 v[108:111], v2, s[36:39], s18 offen sc1
KF_S22:
    v_exp_f32 v56, v56
    v_exp_f32 v57, v57
    v_exp_f32 v58, v58
    v_exp_f32 v59, v59
    v_cvt_pk_bf16_f32 v24, v56, v57
    v_cvt_pk_bf16_f32 v25, v58, v59
    v_mfma_f32_32x32x16_bf16 v[32:47], v[48:51], v[28:31], v[32:47]
    ds_read_b128 v[120:123], v22 offset:7872
    ds_read_b64 v[96:97], v21 offset:10496
    v_exp_f32 v60, v60
    v_exp_f32 v61, v61
    v_exp_f32 v62, v62
    v_exp_f32 v63, v63
    v_cvt_pk_bf16_f32 v26, v60, v61
    v_cvt_pk_bf16_f32 v27, v62, v63
    v_mfma_f32_32x32x8_bf16 v[72:87], v[98:99], v[16:17], v[72:87]
    v_exp_f32 v64, v64
    v_exp_f32 v65, v65
    v_exp_f32 v66, v66
    v_exp_f32 v67, v67
    v_cvt_pk_bf16_f32 v28, v64, v65
    v_cvt_pk_bf16_f32 v29, v66, v67
    v_mfma_f32_32x32x16_bf16 v[32:47], v[116:119], v[24:27], v[32:47]
    v_exp_f32 v68, v68
    v_exp_f32 v69, v69
    v_exp_f32 v70, v70
    v_exp_f32 v71, v71
    v_cvt_pk_bf16_f32 v30, v68, v69
    v_cvt_pk_bf16_f32 v31, v70, v71
    s_waitcnt lgkmcnt(0)
    v_mfma_f32_32x32x16_bf16 v[56:71], v[88:91], v[12:15], 0
    ds_read_b128 v[48:51], v23 offset:7872
    ds_read_b128 v[92:95], v20 offset:13120
    s_cmp_lg_u32 s10, 2
    s_cbranch_scc1 KF_S23
    s_cmp_eq_u32 s22, 1
    s_cbranch_scc1 KF_SQ23_V
    buffer_store_dwordx2 v[112:113], v19, s[36:39], s19 offen sc1
    buffer_store_dwordx2 v[114:115], v9, s[36:39], s20 offen sc1
    s_branch KF_SQ23_E
KF_SQ23_V:
    buffer_store_dwordx4 v[112:115], v2, s[36:39], s19 offen sc1
KF_SQ23_E:
KF_S23:
    v_exp_f32 v72, v72
    v_exp_f32 v73, v73
    v_exp_f32 v74, v74
    v_exp_f32 v75, v75
    v_cvt_pk_bf16_f32 v24, v72, v73
    v_cvt_pk_bf16_f32 v25, v74, v75
    v_mfma_f32_32x32x16_bf16 v[32:47], v[52:55], v[28:31], v[32:47]
    ds_read_b128 v[116:119], v22 offset:10496
    ds_read_b64 v[98:99], v21 offset:13120
    v_exp_f32 v76, v76
    v_exp_f32 v77, v77
    v_exp_f32 v78, v78
    v_exp_f32 v79, v79
    v_cvt_pk_bf16_f32 v26, v76, v77
    v_cvt_pk_bf16_f32 v27, v78, v79
    v_mfma_f32_32x32x8_bf16 v[56:71], v[96:97], v[16:17], v[56:71]
    v_exp_f32 v80, v80
    v_exp_f32 v81, v81
    v_exp_f32 v82, v82
    v_exp_f32 v83, v83
    v_cvt_pk_bf16_f32 v28, v80, v81
    v_cvt_pk_bf16_f32 v29, v82, v83
    v_mfma_f32_32x32x16_bf16 v[32:47], v[120:123], v[24:27], v[32:47]
    v_exp_f32 v84, v84
    v_exp_f32 v85, v85
    v_exp_f32 v86, v86
    v_exp_f32 v87, v87
    v_cvt_pk_bf16_f32 v30, v84, v85
    v_cvt_pk_bf16_f32 v31, v86, v87
    s_setprio 0
    s_waitcnt lgkmcnt(0)
    v_mfma_f32_32x32x16_bf16 v[72:87], v[92:95], v[12:15], 0
    ds_read_b128 v[52:55], v23 offset:10496
    ds_read_b128 v[88:91], v20 offset:15744
    s_getreg_b32 s13, hwreg(HW_REG_IB_STS, 0, 4)
    s_add_u32 s13, s13, s21
    s_cmp_gt_u32 s13, 0
    s_cbranch_scc1 KF_ACKB104
    s_waitcnt vmcnt(0)
    s_call_b64 s[26:27], KF_ACK
KF_ACKB104:
    v_exp_f32 v56, v56
    v_exp_f32 v57, v57
    v_exp_f32 v58, v58
    v_exp_f32 v59, v59
    v_cvt_pk_bf16_f32 v24, v56, v57
    v_cvt_pk_bf16_f32 v25, v58, v59
    v_mfma_f32_32x32x16_bf16 v[32:47], v[48:51], v[28:31], v[32:47]
    ds_read_b128 v[120:123], v22 offset:13120
    ds_read_b64 v[96:97], v21 offset:15744
    v_exp_f32 v60, v60
    v_exp_f32 v61, v61
    v_exp_f32 v62, v62
    v_exp_f32 v63, v63
    v_cvt_pk_bf16_f32 v26, v60, v61
    v_cvt_pk_bf16_f32 v27, v62, v63
    v_mfma_f32_32x32x8_bf16 v[72:87], v[98:99], v[16:17], v[72:87]
    v_exp_f32 v64, v64
    v_exp_f32 v65, v65
    v_exp_f32 v66, v66
    v_exp_f32 v67, v67
    v_cvt_pk_bf16_f32 v28, v64, v65
    v_cvt_pk_bf16_f32 v29, v66, v67
    v_mfma_f32_32x32x16_bf16 v[32:47], v[116:119], v[24:27], v[32:47]
    v_exp_f32 v68, v68
    v_exp_f32 v69, v69
    v_exp_f32 v70, v70
    v_exp_f32 v71, v71
    v_cvt_pk_bf16_f32 v30, v68, v69
    v_cvt_pk_bf16_f32 v31, v70, v71
    s_waitcnt lgkmcnt(0)
    v_mfma_f32_32x32x16_bf16 v[56:71], v[88:91], v[12:15], 0
    ds_read_b128 v[48:51], v23 offset:13120
    ds_read_b128 v[92:95], v20 offset:18368
    s_getreg_b32 s13, hwreg(HW_REG_IB_STS, 0, 4)
    s_add_u32 s13, s13, s21
    s_cmp_gt_u32 s13, 0
    s_cbranch_scc1 KF_ACKB105
    s_waitcnt vmcnt(0)
    s_call_b64 s[26:27], KF_ACK
KF_ACKB105:
    v_exp_f32 v72, v72
    v_exp_f32 v73, v73
    v_exp_f32 v74, v74
    v_exp_f32 v75, v75
    v_cvt_pk_bf16_f32 v24, v72, v73
    v_cvt_pk_bf16_f32 v25, v74, v75
    v_mfma_f32_32x32x16_bf16 v[32:47], v[52:55], v[28:31], v[32:47]
    ds_read_b128 v[116:119], v22 offset:15744
    ds_read_b64 v[98:99], v21 offset:18368
    v_exp_f32 v76, v76
    v_exp_f32 v77, v77
    v_exp_f32 v78, v78
    v_exp_f32 v79, v79
    v_cvt_pk_bf16_f32 v26, v76, v77
    v_cvt_pk_bf16_f32 v27, v78, v79
    v_mfma_f32_32x32x8_bf16 v[56:71], v[96:97], v[16:17], v[56:71]
    v_exp_f32 v80, v80
    v_exp_f32 v81, v81
    v_exp_f32 v82, v82
    v_exp_f32 v83, v83
    v_cvt_pk_bf16_f32 v28, v80, v81
    v_cvt_pk_bf16_f32 v29, v82, v83
    v_mfma_f32_32x32x16_bf16 v[32:47], v[120:123], v[24:27], v[32:47]
    v_exp_f32 v84, v84
    v_exp_f32 v85, v85
    v_exp_f32 v86, v86
    v_exp_f32 v87, v87
    v_cvt_pk_bf16_f32 v30, v84, v85
    v_cvt_pk_bf16_f32 v31, v86, v87
    s_barrier
    v_add_u32 v20, s25, v20
    v_add_u32 v21, s25, v21
    s_setprio 2
    s_waitcnt lgkmcnt(0)
    v_mfma_f32_32x32x16_bf16 v[72:87], v[92:95], v[12:15], 0
    ds_read_b128 v[52:55], v23 offset:15744
    ds_read_b128 v[88:91], v20 offset:0
    s_getreg_b32 s13, hwreg(HW_REG_IB_STS, 0, 4)
    s_add_u32 s13, s13, s21
    s_cmp_gt_u32 s13, 0
    s_cbranch_scc1 KF_ACKB106
    s_waitcnt vmcnt(0)
    s_call_b64 s[26:27], KF_ACK
KF_ACKB106:
    v_exp_f32 v56, v56
    v_exp_f32 v57, v57
    v_exp_f32 v58, v58
    v_exp_f32 v59, v59
    v_cvt_pk_bf16_f32 v24, v56, v57
    v_cvt_pk_bf16_f32 v25, v58, v59
    v_mfma_f32_32x32x16_bf16 v[32:47], v[48:51], v[28:31], v[32:47]
    ds_read_b128 v[120:123], v22 offset:18368
    ds_read_b64 v[96:97], v21 offset:0
    v_exp_f32 v60, v60
    v_exp_f32 v61, v61
    v_exp_f32 v62, v62
    v_exp_f32 v63, v63
    v_cvt_pk_bf16_f32 v26, v60, v61
    v_cvt_pk_bf16_f32 v27, v62, v63
    v_mfma_f32_32x32x8_bf16 v[72:87], v[98:99], v[16:17], v[72:87]
    v_exp_f32 v64, v64
    v_exp_f32 v65, v65
    v_exp_f32 v66, v66
    v_exp_f32 v67, v67
    v_cvt_pk_bf16_f32 v28, v64, v65
    v_cvt_pk_bf16_f32 v29, v66, v67
    v_mfma_f32_32x32x16_bf16 v[32:47], v[116:119], v[24:27], v[32:47]
    v_exp_f32 v68, v68
    v_exp_f32 v69, v69
    v_exp_f32 v70, v70
    v_exp_f32 v71, v71
    v_cvt_pk_bf16_f32 v30, v68, v69
    v_cvt_pk_bf16_f32 v31, v70, v71
    v_add_u32 v22, s25, v22
    s_waitcnt lgkmcnt(0)
    v_mfma_f32_32x32x16_bf16 v[56:71], v[88:91], v[12:15], 0
    ds_read_b128 v[48:51], v23 offset:18368
    ds_read_b128 v[92:95], v20 offset:2624
    s_cmp_lg_u32 s21, 0
    s_cbranch_scc1 KF_ACKB107
    s_waitcnt vmcnt(0)
    s_call_b64 s[26:27], KF_ACK
KF_ACKB107:
    s_lshl_b32 s16, s5, 5
    s_add_u32 s16, s16, s4
    s_mul_i32 s16, s16, 1280
    s_add_u32 s16, s16, 0x1000000
    v_mov_b32 v9, 0x40000000
    v_lshlrev_b32 v10, 3, v3
    v_mov_b32 v100, -1
    v_mov_b32 v101, -1
    v_mov_b32 v102, -1
    v_mov_b32 v103, -1
    v_cndmask_b32 v9, v9, v10, s[14:15]
    buffer_store_dwordx4 v[100:103], v2, s[36:39], s16 offen sc1
    buffer_store_dwordx2 v[100:101], v9, s[36:39], s16 offen offset:1024 sc1
    s_lshl_b32 s8, s5, 2
    s_lshr_b32 s13, s4, 3
    s_add_u32 s8, s8, s13
    s_mul_i32 s8, s8, 64
    s_add_u32 s8, s8, 0x1b00000
    s_bitcmp1_b32 s4, 2
    s_cselect_b32 s17, 0x100, 1
    v_exp_f32 v72, v72
    v_exp_f32 v73, v73
    v_exp_f32 v74, v74
    v_exp_f32 v75, v75
    v_cvt_pk_bf16_f32 v24, v72, v73
    v_cvt_pk_bf16_f32 v25, v74, v75
    v_mfma_f32_32x32x16_bf16 v[32:47], v[52:55], v[28:31], v[32:47]
    ds_read_b128 v[116:119], v22 offset:0
    ds_read_b64 v[98:99], v21 offset:2624
    v_add_u32 v23, s25, v23
    v_exp_f32 v76, v76
    v_exp_f32 v77, v77
    v_exp_f32 v78, v78
    v_exp_f32 v79, v79
    v_cvt_pk_bf16_f32 v26, v76, v77
    v_cvt_pk_bf16_f32 v27, v78, v79
    v_mfma_f32_32x32x8_bf16 v[56:71], v[96:97], v[16:17], v[56:71]
    v_exp_f32 v80, v80
    v_exp_f32 v81, v81
    v_exp_f32 v82, v82
    v_exp_f32 v83, v83
    v_cvt_pk_bf16_f32 v28, v80, v81
    v_cvt_pk_bf16_f32 v29, v82, v83
    v_mfma_f32_32x32x16_bf16 v[32:47], v[120:123], v[24:27], v[32:47]
    s_add_u32 s9, s9, 1
    s_cmp_lg_u32 s9, 8
    v_exp_f32 v84, v84
    v_exp_f32 v85, v85
    v_exp_f32 v86, v86
    v_exp_f32 v87, v87
    v_cvt_pk_bf16_f32 v30, v84, v85
    v_cvt_pk_bf16_f32 v31, v86, v87
KF_LOOP:
    s_add_u32 s12, s12, 1
    s_cmp_eq_u32 s12, 3
    s_cselect_b32 s25, 41984, s32
    s_cselect_b32 s12, 0, s12
    s_waitcnt lgkmcnt(0)
    v_mfma_f32_32x32x16_bf16 v[72:87], v[92:95], v[12:15], 0
    ds_read_b128 v[52:55], v23 offset:0
    ds_read_b128 v[88:91], v20 offset:5248
    v_exp_f32 v56, v56
    v_exp_f32 v57, v57
    v_exp_f32 v58, v58
    v_exp_f32 v59, v59
    v_cvt_pk_bf16_f32 v24, v56, v57
    v_cvt_pk_bf16_f32 v25, v58, v59
    v_mfma_f32_32x32x16_bf16 v[32:47], v[48:51], v[28:31], v[32:47]
    ds_read_b128 v[120:123], v22 offset:2624
    ds_read_b64 v[96:97], v21 offset:5248
    v_exp_f32 v60, v60
    v_exp_f32 v61, v61
    v_exp_f32 v62, v62
    v_exp_f32 v63, v63
    v_cvt_pk_bf16_f32 v26, v60, v61
    v_cvt_pk_bf16_f32 v27, v62, v63
    v_mfma_f32_32x32x8_bf16 v[72:87], v[98:99], v[16:17], v[72:87]
    v_exp_f32 v64, v64
    v_exp_f32 v65, v65
    v_exp_f32 v66, v66
    v_exp_f32 v67, v67
    v_cvt_pk_bf16_f32 v28, v64, v65
    v_cvt_pk_bf16_f32 v29, v66, v67
    v_mfma_f32_32x32x16_bf16 v[32:47], v[116:119], v[24:27], v[32:47]
    v_exp_f32 v68, v68
    v_exp_f32 v69, v69
    v_exp_f32 v70, v70
    v_exp_f32 v71, v71
    v_cvt_pk_bf16_f32 v30, v68, v69
    v_cvt_pk_bf16_f32 v31, v70, v71
    s_waitcnt lgkmcnt(0)
    v_mfma_f32_32x32x16_bf16 v[56:71], v[88:91], v[12:15], 0
    ds_read_b128 v[48:51], v23 offset:2624
    ds_read_b128 v[92:95], v20 offset:7872
    v_exp_f32 v72, v72
    v_exp_f32 v73, v73
    v_exp_f32 v74, v74
    v_exp_f32 v75, v75
    v_cvt_pk_bf16_f32 v24, v72, v73
    v_cvt_pk_bf16_f32 v25, v74, v75
    v_mfma_f32_32x32x16_bf16 v[32:47], v[52:55], v[28:31], v[32:47]
    ds_read_b128 v[116:119], v22 offset:5248
    ds_read_b64 v[98:99], v21 offset:7872
    v_exp_f32 v76, v76
    v_exp_f32 v77, v77
    v_exp_f32 v78, v78
    v_exp_f32 v79, v79
    v_cvt_pk_bf16_f32 v26, v76, v77
    v_cvt_pk_bf16_f32 v27, v78, v79
    v_mfma_f32_32x32x8_bf16 v[56:71], v[96:97], v[16:17], v[56:71]
    v_exp_f32 v80, v80
    v_exp_f32 v81, v81
    v_exp_f32 v82, v82
    v_exp_f32 v83, v83
    v_cvt_pk_bf16_f32 v28, v80, v81
    v_cvt_pk_bf16_f32 v29, v82, v83
    v_mfma_f32_32x32x16_bf16 v[32:47], v[120:123], v[24:27], v[32:47]
    v_exp_f32 v84, v84
    v_exp_f32 v85, v85
    v_exp_f32 v86, v86
    v_exp_f32 v87, v87
    v_cvt_pk_bf16_f32 v30, v84, v85
    v_cvt_pk_bf16_f32 v31, v86, v87
    s_setprio 1
    s_waitcnt lgkmcnt(0)
    v_mfma_f32_32x32x16_bf16 v[72:87], v[92:95], v[12:15], 0
    ds_read_b128 v[52:55], v23 offset:5248
    ds_read_b128 v[88:91], v20 offset:10496
    v_exp_f32 v56, v56
    v_exp_f32 v57, v57
    v_exp_f32 v58, v58
    v_exp_f32 v59, v59
    v_cvt_pk_bf16_f32 v24, v56, v57
    v_cvt_pk_bf16_f32 v25, v58, v59
    v_mfma_f32_32x32x16_bf16 v[32:47], v[48:51], v[28:31], v[32:47]
    ds_read_b128 v[120:123], v22 offset:7872
    ds_read_b64 v[96:97], v21 offset:10496
    v_exp_f32 v60, v60
    v_exp_f32 v61, v61
    v_exp_f32 v62, v62
    v_exp_f32 v63, v63
    v_cvt_pk_bf16_f32 v26, v60, v61
    v_cvt_pk_bf16_f32 v27, v62, v63
    v_mfma_f32_32x32x8_bf16 v[72:87], v[98:99], v[16:17], v[72:87]
    v_exp_f32 v64, v64
    v_exp_f32 v65, v65
    v_exp_f32 v66, v66
    v_exp_f32 v67, v67
    v_cvt_pk_bf16_f32 v28, v64, v65
    v_cvt_pk_bf16_f32 v29, v66, v67
    v_mfma_f32_32x32x16_bf16 v[32:47], v[116:119], v[24:27], v[32:47]
    v_exp_f32 v68, v68
    v_exp_f32 v69, v69
    v_exp_f32 v70, v70
    v_exp_f32 v71, v71
    v_cvt_pk_bf16_f32 v30, v68, v69
    v_cvt_pk_bf16_f32 v31, v70, v71
    s_cmp_lg_u32 s9, 7
    s_cbranch_scc1 KF_ARRX
    v_mov_b32 v10, 1
    s_mov_b64 exec, 1
    ds_add_u32 v0, v10 offset:64592
    s_mov_b64 exec, -1
KF_ARRX:
    s_waitcnt lgkmcnt(0)
    v_mfma_f32_32x32x16_bf16 v[56:71], v[88:91], v[12:15], 0
    ds_read_b128 v[48:51], v23 offset:7872
    ds_read_b128 v[92:95], v20 offset:13120
    v_exp_f32 v72, v72
    v_exp_f32 v73, v73
    v_exp_f32 v74, v74
    v_exp_f32 v75, v75
    v_cvt_pk_bf16_f32 v24, v72, v73
    v_cvt_pk_bf16_f32 v25, v74, v75
    v_mfma_f32_32x32x16_bf16 v[32:47], v[52:55], v[28:31], v[32:47]
    ds_read_b128 v[116:119], v22 offset:10496
    ds_read_b64 v[98:99], v21 offset:13120
    v_exp_f32 v76, v76
    v_exp_f32 v77, v77
    v_exp_f32 v78, v78
    v_exp_f32 v79, v79
    v_cvt_pk_bf16_f32 v26, v76, v77
    v_cvt_pk_bf16_f32 v27, v78, v79
    v_mfma_f32_32x32x8_bf16 v[56:71], v[96:97], v[16:17], v[56:71]
    v_exp_f32 v80, v80
    v_exp_f32 v81, v81
    v_exp_f32 v82, v82
    v_exp_f32 v83, v83
    v_cvt_pk_bf16_f32 v28, v80, v81
    v_cvt_pk_bf16_f32 v29, v82, v83
    v_mfma_f32_32x32x16_bf16 v[32:47], v[120:123], v[24:27], v[32:47]
    v_exp_f32 v84, v84
    v_exp_f32 v85, v85
    v_exp_f32 v86, v86
    v_exp_f32 v87, v87
    v_cvt_pk_bf16_f32 v30, v84, v85
    v_cvt_pk_bf16_f32 v31, v86, v87
    s_setprio 0
    s_waitcnt lgkmcnt(0)
    v_mfma_f32_32x32x16_bf16 v[72:87], v[92:95], v[12:15], 0
    ds_read_b128 v[52:55], v23 offset:10496
    ds_read_b128 v[88:91], v20 offset:15744
    v_exp_f32 v56, v56
    v_exp_f32 v57, v57
    v_exp_f32 v58, v58
    v_exp_f32 v59, v59
    v_cvt_pk_bf16_f32 v24, v56, v57
    v_cvt_pk_bf16_f32 v25, v58, v59
    v_mfma_f32_32x32x16_bf16 v[32:47], v[48:51], v[28:31], v[32:47]
    ds_read_b128 v[120:123], v22 offset:13120
    ds_read_b64 v[96:97], v21 offset:15744
    v_exp_f32 v60, v60
    v_exp_f32 v61, v61
    v_exp_f32 v62, v62
    v_exp_f32 v63, v63
    v_cvt_pk_bf16_f32 v26, v60, v61
    v_cvt_pk_bf16_f32 v27, v62, v63
    v_mfma_f32_32x32x8_bf16 v[72:87], v[98:99], v[16:17], v[72:87]
    v_exp_f32 v64, v64
    v_exp_f32 v65, v65
    v_exp_f32 v66, v66
    v_exp_f32 v67, v67
    v_cvt_pk_bf16_f32 v28, v64, v65
    v_cvt_pk_bf16_f32 v29, v66, v67
    v_mfma_f32_32x32x16_bf16 v[32:47], v[116:119], v[24:27], v[32:47]
    v_exp_f32 v68, v68
    v_exp_f32 v69, v69
    v_exp_f32 v70, v70
    v_exp_f32 v71, v71
    v_cvt_pk_bf16_f32 v30, v68, v69
    v_cvt_pk_bf16_f32 v31, v70, v71
    s_waitcnt lgkmcnt(0)
    v_mfma_f32_32x32x16_bf16 v[56:71], v[88:91], v[12:15], 0
    ds_read_b128 v[48:51], v23 offset:13120
    ds_read_b128 v[92:95], v20 offset:18368
    v_exp_f32 v72, v72
    v_exp_f32 v73, v73
    v_exp_f32 v74, v74
    v_exp_f32 v75, v75
    v_cvt_pk_bf16_f32 v24, v72, v73
    v_cvt_pk_bf16_f32 v25, v74, v75
    v_mfma_f32_32x32x16_bf16 v[32:47], v[52:55], v[28:31], v[32:47]
    ds_read_b128 v[116:119], v22 offset:15744
    ds_read_b64 v[98:99], v21 offset:18368
    v_exp_f32 v76, v76
    v_exp_f32 v77, v77
    v_exp_f32 v78, v78
    v_exp_f32 v79, v79
    v_cvt_pk_bf16_f32 v26, v76, v77
    v_cvt_pk_bf16_f32 v27, v78, v79
    v_mfma_f32_32x32x8_bf16 v[56:71], v[96:97], v[16:17], v[56:71]
    v_exp_f32 v80, v80
    v_exp_f32 v81, v81
    v_exp_f32 v82, v82
    v_exp_f32 v83, v83
    v_cvt_pk_bf16_f32 v28, v80, v81
    v_cvt_pk_bf16_f32 v29, v82, v83
    v_mfma_f32_32x32x16_bf16 v[32:47], v[120:123], v[24:27], v[32:47]
    v_exp_f32 v84, v84
    v_exp_f32 v85, v85
    v_exp_f32 v86, v86
    v_exp_f32 v87, v87
    v_cvt_pk_bf16_f32 v30, v84, v85
    v_cvt_pk_bf16_f32 v31, v86, v87
    s_cmp_eq_u32 s9, 7
    s_cbranch_scc1 KF_BARX
    s_barrier
KF_BARX:
    v_add_u32 v20, s25, v20
    v_add_u32 v21, s25, v21
    s_setprio 2
    s_waitcnt lgkmcnt(0)
    v_mfma_f32_32x32x16_bf16 v[72:87], v[92:95], v[12:15], 0
    ds_read_b128 v[52:55], v23 offset:15744
    ds_read_b128 v[88:91], v20 offset:0
    v_exp_f32 v56, v56
    v_exp_f32 v57, v57
    v_exp_f32 v58, v58
    v_exp_f32 v59, v59
    v_cvt_pk_bf16_f32 v24, v56, v57
    v_cvt_pk_bf16_f32 v25, v58, v59
    v_mfma_f32_32x32x16_bf16 v[32:47], v[48:51], v[28:31], v[32:47]
    ds_read_b128 v[120:123], v22 offset:18368
    ds_read_b64 v[96:97], v21 offset:0
    v_exp_f32 v60, v60
    v_exp_f32 v61, v61
    v_exp_f32 v62, v62
    v_exp_f32 v63, v63
    v_cvt_pk_bf16_f32 v26, v60, v61
    v_cvt_pk_bf16_f32 v27, v62, v63
    v_mfma_f32_32x32x8_bf16 v[72:87], v[98:99], v[16:17], v[72:87]
    v_exp_f32 v64, v64
    v_exp_f32 v65, v65
    v_exp_f32 v66, v66
    v_exp_f32 v67, v67
    v_cvt_pk_bf16_f32 v28, v64, v65
    v_cvt_pk_bf16_f32 v29, v66, v67
    v_mfma_f32_32x32x16_bf16 v[32:47], v[116:119], v[24:27], v[32:47]
    v_exp_f32 v68, v68
    v_exp_f32 v69, v69
    v_exp_f32 v70, v70
    v_exp_f32 v71, v71
    v_cvt_pk_bf16_f32 v30, v68, v69
    v_cvt_pk_bf16_f32 v31, v70, v71
    v_add_u32 v22, s25, v22
    s_waitcnt lgkmcnt(0)
    v_mfma_f32_32x32x16_bf16 v[56:71], v[88:91], v[12:15], 0
    ds_read_b128 v[48:51], v23 offset:18368
    ds_read_b128 v[92:95], v20 offset:2624
    v_exp_f32 v72, v72
    v_exp_f32 v73, v73
    v_exp_f32 v74, v74
    v_exp_f32 v75, v75
    v_cvt_pk_bf16_f32 v24, v72, v73
    v_cvt_pk_bf16_f32 v25, v74, v75
    v_mfma_f32_32x32x16_bf16 v[32:47], v[52:55], v[28:31], v[32:47]
    ds_read_b128 v[116:119], v22 offset:0
    ds_read_b64 v[98:99], v21 offset:2624
    v_add_u32 v23, s25, v23
    v_exp_f32 v76, v76
    v_exp_f32 v77, v77
    v_exp_f32 v78, v78
    v_exp_f32 v79, v79
    v_cvt_pk_bf16_f32 v26, v76, v77
    v_cvt_pk_bf16_f32 v27, v78, v79
    v_mfma_f32_32x32x8_bf16 v[56:71], v[96:97], v[16:17], v[56:71]
    v_exp_f32 v80, v80
    v_exp_f32 v81, v81
    v_exp_f32 v82, v82
    v_exp_f32 v83, v83
    v_cvt_pk_bf16_f32 v28, v80, v81
    v_cvt_pk_bf16_f32 v29, v82, v83
    v_mfma_f32_32x32x16_bf16 v[32:47], v[120:123], v[24:27], v[32:47]
    s_add_u32 s9, s9, 1
    s_cmp_lg_u32 s9, 8
    v_exp_f32 v84, v84
    v_exp_f32 v85, v85
    v_exp_f32 v86, v86
    v_exp_f32 v87, v87
    v_cvt_pk_bf16_f32 v30, v84, v85
    v_cvt_pk_bf16_f32 v31, v86, v87
    s_cbranch_scc1 KF_LOOP
    s_waitcnt lgkmcnt(0)
    v_mfma_f32_32x32x16_bf16 v[32:47], v[48:51], v[28:31], v[32:47]
    s_mov_b32 s18, 0
    v_mov_b32 v10, s17
    v_mul_u32_u24 v11, 64, v0
    s_mov_b64 exec, 1
    s_waitcnt vmcnt(0)
    buffer_atomic_add v10, v11, s[36:39], s8 offen sc1
    s_mov_b64 exec, -1
    s_nop 6
KF_FINISH:
    v_mov_b32 v6, v40
    v_mov_b32 v7, v40
    s_nop 1
    v_permlane32_swap_b32 v6, v7
    s_nop 1
    v_rcp_f32 v6, v7
    v_cmp_le_f32 vcc, 0x30800000, v7
    v_mov_b32 v11, 0x71800000
    v_cmp_ge_f32 s[20:21], v11, v7
    v_mov_b32 v8, 0
    v_mov_b32 v10, 0
    v_mul_f32 v6, v6, v124
    v_mul_f32 v32, v32, v6
    v_mul_f32 v33, v33, v6
    v_mul_f32 v34, v34, v6
    v_mul_f32 v35, v35, v6
    v_mul_f32 v36, v36, v6
    v_mul_f32 v37, v37, v6
    v_mul_f32 v38, v38, v6
    v_mul_f32 v39, v39, v6
    v_mul_f32 v40, v40, v6
    v_mul_f32 v41, v41, v6
    v_mul_f32 v42, v42, v6
    v_mul_f32 v43, v43, v6
    v_fma_f32 v8, v32, 0, v8
    v_fma_f32 v8, v33, 0, v8
    v_fma_f32 v8, v34, 0, v8
    v_fma_f32 v8, v35, 0, v8
    v_fma_f32 v8, v36, 0, v8
    v_fma_f32 v8, v37, 0, v8
    v_fma_f32 v8, v38, 0, v8
    v_fma_f32 v8, v39, 0, v8
    v_fma_f32 v10, v40, 0, v10
    v_fma_f32 v10, v41, 0, v10
    v_fma_f32 v10, v42, 0, v10
    v_fma_f32 v10, v43, 0, v10
    s_and_b64 s[20:21], s[20:21], vcc
    v_cndmask_b32 v10, 0, v10, s[14:15]
    v_add_f32 v8, v8, v10
    v_cmp_eq_f32 vcc, 0, v8
    s_and_b64 s[20:21], s[20:21], vcc
    s_cmp_eq_u64 s[20:21], -1
    s_cselect_b32 s19, 1, s18
    s_cmp_eq_u32 s19, 0
    s_cbranch_scc1 KF_FALLBACK
    v_cvt_pk_bf16_f32 v24, v32, v33
    v_cvt_pk_bf16_f32 v25, v34, v35
    v_cvt_pk_bf16_f32 v26, v36, v37
    v_cvt_pk_bf16_f32 v27, v38, v39
    v_cvt_pk_bf16_f32 v28, v40, v41
    v_cvt_pk_bf16_f32 v29, v42, v43
    v_min_u32 v24, -2, v24
    v_min_u32 v25, -2, v25
    v_min_u32 v26, -2, v26
    v_min_u32 v27, -2, v27
    v_min_u32 v28, -2, v28
    v_min_u32 v29, -2, v29
    buffer_store_dwordx4 v[24:27], v2, s[36:39], s16 offen sc1
    buffer_store_dwordx2 v[28:29], v9, s[36:39], s16 offen offset:1024 sc1
    s_cmp_ge_u32 s3, 5
    s_cbranch_scc1 KF_DONE
    s_lshl_b32 s15, s3, 4
    s_add_u32 s13, s15, 64512
    v_mov_b32 v4, s13
    s_and_b32 s4, s2, 7
    s_lshl_b32 s4, s4, 3
    s_bfe_u32 s5, s2, 0x30003
    s_add_u32 s4, s4, s5
    s_lshr_b32 s5, s2, 6
    s_mul_i32 s14, s4, 40960
    s_mul_i32 s5, s5, 320
    s_lshl_b32 s15, s15, 2
    s_add_u32 s14, s14, s5
    s_add_u32 s14, s14, s15
    s_mul_i32 s13, s3, 4608
    s_add_u32 s13, s13, 65536
    v_lshrrev_b32 v6, 1, v0
    v_and_b32 v7, 1, v0
    v_mul_u32_u24 v5, 144, v6
    v_lshl_add_u32 v5, v7, 6, v5
    v_mul_u32_u24 v6, 1280, v6
    v_lshl_add_u32 v6, v7, 5, v6
    s_mov_b32 s9, 0
    s_mov_b32 s26, 0
    v_mov_b32 v40, 0
    v_mov_b32 v41, 0
    v_mov_b32 v42, 0
    v_mov_b32 v43, 0
    v_mov_b32 v44, 0
    v_mov_b32 v45, 0
    v_mov_b32 v46, 0
    v_mov_b32 v47, 0
    v_mov_b32 v48, 0
    v_mov_b32 v49, 0
    v_mov_b32 v50, 0
    v_mov_b32 v51, 0
    v_mov_b32 v52, 0
    v_mov_b32 v53, 0
    v_mov_b32 v54, 0
    v_mov_b32 v55, 0
KF_RD:
    ds_read_b32 v8, v4
KF_RD2:
    s_add_u32 s26, s26, 1
    s_waitcnt lgkmcnt(0)
    v_readfirstlane_b32 s15, v8
    s_cmp_gt_u32 s26, 3200000
    s_cbranch_scc1 KF_RDX
    s_andn2_b32 s15, s15, s9
    s_cbranch_scc0 KF_RD
    s_ff1_i32_b32 s12, s15
    s_bitset1_b32 s9, s12
    s_mul_i32 s12, s12, 24576
    s_add_u32 s12, s12, s13
    v_add_u32 v7, s12, v5
    ds_read_b128 v[56:59], v7 offset:0
    ds_read_b128 v[60:63], v7 offset:16
    ds_read_b128 v[64:67], v7 offset:32
    ds_read_b128 v[68:71], v7 offset:48
    ds_read_b32 v8, v4
    s_cmp_lg_u32 s9, 15
    s_waitcnt lgkmcnt(4)
    v_pk_add_f32 v[40:41], v[40:41], v[56:57]
    v_pk_add_f32 v[42:43], v[42:43], v[58:59]
    s_waitcnt lgkmcnt(3)
    v_pk_add_f32 v[44:45], v[44:45], v[60:61]
    v_pk_add_f32 v[46:47], v[46:47], v[62:63]
    s_waitcnt lgkmcnt(2)
    v_pk_add_f32 v[48:49], v[48:49], v[64:65]
    v_pk_add_f32 v[50:51], v[50:51], v[66:67]
    s_waitcnt lgkmcnt(1)
    v_pk_add_f32 v[52:53], v[52:53], v[68:69]
    v_pk_add_f32 v[54:55], v[54:55], v[70:71]
    s_cbranch_scc1 KF_RD2
KF_RDX:
    v_cvt_pk_bf16_f32 v56, v40, v41
    v_cvt_pk_bf16_f32 v57, v42, v43
    v_cvt_pk_bf16_f32 v58, v44, v45
    v_cvt_pk_bf16_f32 v59, v46, v47
    buffer_store_dwordx4 v[56:59], v6, s[40:43], s14 offen offset:0
    v_cvt_pk_bf16_f32 v60, v48, v49
    v_cvt_pk_bf16_f32 v61, v50, v51
    v_cvt_pk_bf16_f32 v62, v52, v53
    v_cvt_pk_bf16_f32 v63, v54, v55
    buffer_store_dwordx4 v[60:63], v6, s[40:43], s14 offen offset:16
KF_DONE:
KF_END:
    s_endpgm
KF_FALLBACK:
    s_mov_b32 s18, 1
    v_cndmask_b32 v16, 0, v16, s[14:15]
    v_lshlrev_b32 v5, 3, v3
    v_mov_b32 v6, 0x40000000
    v_cndmask_b32 v5, v6, v5, s[14:15]
    s_mul_i32 s11, s4, 20
    s_mul_i32 s9, s4, 1280
    s_sub_u32 s9, 40960, s9
    v_add_u32 v7, s11, v3
    v_lshrrev_b32 v8, 5, v7
    v_and_b32 v7, 31, v7
    v_lshlrev_b32 v8, 11, v8
    v_lshl_add_u32 v8, v7, 4, v8
    v_lshl_add_u32 v8, v4, 9, v8
    v_cmp_gt_u32 vcc, 20, v3
    v_add_u32 v8, s9, v8
    v_cmp_eq_u32 s[22:23], 20, v3
    v_cndmask_b32 v22, v6, v8, vcc
    v_mov_b32 v21, 0x3f803f80
    v_mov_b32 v23, 0xff800000
    s_mov_b32 s11, s6
    s_mov_b32 s9, 0
KF_FB1:
    buffer_load_dwordx4 v[88:91], v2, s[36:39], s11 offen
    buffer_load_dwordx2 v[96:97], v5, s[36:39], s11 offen offset:1024
    s_add_u32 s11, s11, 81920
    s_add_u32 s9, s9, 1
    s_waitcnt vmcnt(0)
    v_mfma_f32_32x32x16_bf16 v[56:71], v[88:91], v[12:15], 0
    v_mfma_f32_32x32x8_bf16 v[56:71], v[96:97], v[16:17], v[56:71]
    s_nop 15
    v_max3_f32 v6, v56, v57, v58
    v_max3_f32 v7, v59, v60, v61
    v_max3_f32 v6, v6, v62, v63
    v_max3_f32 v7, v7, v64, v65
    v_max3_f32 v6, v6, v66, v67
    v_max3_f32 v7, v7, v68, v69
    v_max3_f32 v6, v6, v70, v71
    v_max_f32 v6, v6, v7
    v_max_f32 v23, v23, v6
    s_cmp_lg_u32 s9, 64
    s_cbranch_scc1 KF_FB1
    v_mov_b32 v7, v23
    s_nop 1
    v_permlane32_swap_b32 v23, v7
    s_nop 1
    v_max_f32 v23, v23, v7
    v_mov_b32 v32, 0
    v_mov_b32 v33, 0
    v_mov_b32 v34, 0
    v_mov_b32 v35, 0
    v_mov_b32 v36, 0
    v_mov_b32 v37, 0
    v_mov_b32 v38, 0
    v_mov_b32 v39, 0
    v_mov_b32 v40, 0
    v_mov_b32 v41, 0
    v_mov_b32 v42, 0
    v_mov_b32 v43, 0
    v_mov_b32 v44, 0
    v_mov_b32 v45, 0
    v_mov_b32 v46, 0
    v_mov_b32 v47, 0
    s_mov_b32 s11, s6
    s_mov_b32 s9, 0
KF_FB2:
    buffer_load_dwordx4 v[88:91], v2, s[36:39], s11 offen
    buffer_load_dwordx2 v[96:97], v5, s[36:39], s11 offen offset:1024
    buffer_load_dwordx4 v[116:119], v22, s[36:39], s11 offen
    buffer_load_dwordx4 v[52:55], v22, s[36:39], s11 offen offset:1024
    s_add_u32 s11, s11, 81920
    s_add_u32 s9, s9, 1
    s_waitcnt vmcnt(0)
    v_mfma_f32_32x32x16_bf16 v[56:71], v[88:91], v[12:15], 0
    v_mfma_f32_32x32x8_bf16 v[56:71], v[96:97], v[16:17], v[56:71]
    v_cndmask_b32 v116, v116, v21, s[22:23]
    v_cndmask_b32 v52, v52, v21, s[22:23]
    v_cndmask_b32 v117, v117, v21, s[22:23]
    v_cndmask_b32 v53, v53, v21, s[22:23]
    v_cndmask_b32 v118, v118, v21, s[22:23]
    v_cndmask_b32 v54, v54, v21, s[22:23]
    v_cndmask_b32 v119, v119, v21, s[22:23]
    v_cndmask_b32 v55, v55, v21, s[22:23]
    s_nop 15
    v_sub_f32 v56, v56, v23
    v_sub_f32 v57, v57, v23
    v_sub_f32 v58, v58, v23
    v_sub_f32 v59, v59, v23
    v_sub_f32 v60, v60, v23
    v_sub_f32 v61, v61, v23
    v_sub_f32 v62, v62, v23
    v_sub_f32 v63, v63, v23
    v_sub_f32 v64, v64, v23
    v_sub_f32 v65, v65, v23
    v_sub_f32 v66, v66, v23
    v_sub_f32 v67, v67, v23
    v_sub_f32 v68, v68, v23
    v_sub_f32 v69, v69, v23
    v_sub_f32 v70, v70, v23
    v_sub_f32 v71, v71, v23
    v_exp_f32 v56, v56
    v_exp_f32 v57, v57
    v_exp_f32 v58, v58
    v_exp_f32 v59, v59
    v_cvt_pk_bf16_f32 v24, v56, v57
    v_cvt_pk_bf16_f32 v25, v58, v59
    v_exp_f32 v60, v60
    v_exp_f32 v61, v61
    v_exp_f32 v62, v62
    v_exp_f32 v63, v63
    v_cvt_pk_bf16_f32 v26, v60, v61
    v_cvt_pk_bf16_f32 v27, v62, v63
    v_exp_f32 v64, v64
    v_exp_f32 v65, v65
    v_exp_f32 v66, v66
    v_exp_f32 v67, v67
    v_cvt_pk_bf16_f32 v28, v64, v65
    v_cvt_pk_bf16_f32 v29, v66, v67
    v_exp_f32 v68, v68
    v_exp_f32 v69, v69
    v_exp_f32 v70, v70
    v_exp_f32 v71, v71
    v_cvt_pk_bf16_f32 v30, v68, v69
    v_cvt_pk_bf16_f32 v31, v70, v71
    s_nop 1
    v_mfma_f32_32x32x16_bf16 v[32:47], v[116:119], v[24:27], v[32:47]
    v_mfma_f32_32x32x16_bf16 v[32:47], v[52:55], v[28:31], v[32:47]
    s_cmp_lg_u32 s9, 64
    s_nop 7
    s_cbranch_scc1 KF_FB2
    s_nop 15
    s_branch KF_FINISH
KF_ACK:
    s_mov_b32 s21, 64
    v_mov_b32 v5, s24
    v_mov_b32 v6, 1
    s_mov_b64 exec, 1
    ds_add_rtn_u32 v7, v5, v6
    s_mov_b32 exec_lo, s31
    v_lshlrev_b32 v5, 6, v0
    v_mov_b32 v6, s23
    s_waitcnt lgkmcnt(0)
    v_readfirstlane_b32 s13, v7
    s_cmp_lg_u32 s13, 7
    s_cbranch_scc1 KF_ACK_X
    buffer_atomic_add v6, v5, s[36:39], s29 offen sc1
KF_ACK_X:
    s_mov_b64 exec, -1
    s_setpc_b64 s[26:27]
KF_EPI_GATE:
    s_cmp_ge_u32 s3, 4
    s_cbranch_scc1 KF_P2
    s_nop 11
    v_add_f32 v5, v100, v105
    v_add_f32 v6, v110, v115
    v_add_f32 v7, v116, v121
    v_add_f32 v8, v126, v131
    v_cmp_lt_u32 vcc, 31, v0
    v_add_f32 v5, v5, v6
    v_add_f32 v7, v7, v8
    s_nop 1
    v_cndmask_b32 v5, v5, v7, vcc
    v_mov_b32 v6, v5
    s_nop 1
    v_permlane32_swap_b32 v5, v6
    s_nop 1
    v_add_f32 v5, v5, v6
    v_mul_f32 v5, s64, v5
    v_exp_f32 v5, v5
    s_nop 0
    v_add_f32 v5, 1.0, v5
    v_rcp_f32 v5, v5
    s_lshl_b32 s13, s8, 7
    s_add_u32 s13, s13, 0x1300000
    v_lshlrev_b32 v6, 2, v3
    buffer_store_dword v5, v6, s[36:39], s13 offen sc1
    s_branch KF_P2
KF_P1V:
    ds_read_b128 v[20:23], v10 offset:32768
    ds_read_b64_tr_b16 v[132:133], v14 offset:32768
    ds_read_b64_tr_b16 v[134:135], v14 offset:33792
    ds_read_b64_tr_b16 v[136:137], v15 offset:32768
    ds_read_b64_tr_b16 v[138:139], v15 offset:33792
    ds_read_b128 v[156:159], v11 offset:32768
    ds_read_b64_tr_b16 v[148:149], v16 offset:36864
    ds_read_b64_tr_b16 v[150:151], v16 offset:37888
    ds_read_b64_tr_b16 v[152:153], v17 offset:36864
    ds_read_b64_tr_b16 v[154:155], v17 offset:37888
    s_waitcnt lgkmcnt(7)
    v_mfma_f32_32x32x16_bf16 v[100:115], v[20:23], v[132:135], 0
    ds_read_b128 v[24:27], v12 offset:32768
    ds_read_b64_tr_b16 v[140:141], v14 offset:40960
    ds_read_b64_tr_b16 v[142:143], v14 offset:41984
    s_waitcnt lgkmcnt(8)
    v_mfma_f32_32x32x16_bf16 v[116:131], v[20:23], v[136:139], 0
    ds_read_b64_tr_b16 v[144:145], v15 offset:40960
    ds_read_b64_tr_b16 v[146:147], v15 offset:41984
    s_waitcnt lgkmcnt(7)
    v_mfma_f32_32x32x16_bf16 v[100:115], v[156:159], v[148:151], v[100:115]
    ds_read_b128 v[160:163], v13 offset:32768
    ds_read_b64_tr_b16 v[132:133], v16 offset:45056
    ds_read_b64_tr_b16 v[134:135], v16 offset:46080
    s_waitcnt lgkmcnt(8)
    v_mfma_f32_32x32x16_bf16 v[116:131], v[156:159], v[152:155], v[116:131]
    ds_read_b64_tr_b16 v[136:137], v17 offset:45056
    ds_read_b64_tr_b16 v[138:139], v17 offset:46080
    s_waitcnt lgkmcnt(7)
    v_mfma_f32_32x32x16_bf16 v[100:115], v[24:27], v[140:143], v[100:115]
    s_barrier
    ds_read_b128 v[28:31], v10 offset:0
    ds_read_b64_tr_b16 v[148:149], v14 offset:0
    ds_read_b64_tr_b16 v[150:151], v14 offset:1024
    s_waitcnt lgkmcnt(8)
    v_mfma_f32_32x32x16_bf16 v[116:131], v[24:27], v[144:147], v[116:131]
    ds_read_b64_tr_b16 v[152:153], v15 offset:0
    ds_read_b64_tr_b16 v[154:155], v15 offset:1024
    s_waitcnt lgkmcnt(7)
    v_mfma_f32_32x32x16_bf16 v[100:115], v[160:163], v[132:135], v[100:115]
    ds_read_b128 v[156:159], v11 offset:0
    ds_read_b64_tr_b16 v[140:141], v16 offset:4096
    ds_read_b64_tr_b16 v[142:143], v16 offset:5120
    s_waitcnt lgkmcnt(8)
    v_mfma_f32_32x32x16_bf16 v[116:131], v[160:163], v[136:139], v[116:131]
    ds_read_b64_tr_b16 v[144:145], v17 offset:4096
    ds_read_b64_tr_b16 v[146:147], v17 offset:5120
    s_waitcnt lgkmcnt(7)
    v_mfma_f32_32x32x16_bf16 v[100:115], v[28:31], v[148:151], v[100:115]
    ds_read_b128 v[32:35], v12 offset:0
    ds_read_b64_tr_b16 v[132:133], v14 offset:8192
    ds_read_b64_tr_b16 v[134:135], v14 offset:9216
    s_waitcnt lgkmcnt(8)
    v_mfma_f32_32x32x16_bf16 v[116:131], v[28:31], v[152:155], v[116:131]
    ds_read_b64_tr_b16 v[136:137], v15 offset:8192
    ds_read_b64_tr_b16 v[138:139], v15 offset:9216
    s_waitcnt lgkmcnt(7)
    v_mfma_f32_32x32x16_bf16 v[100:115], v[156:159], v[140:143], v[100:115]
    ds_read_b128 v[160:163], v13 offset:0
    ds_read_b64_tr_b16 v[148:149], v16 offset:12288
    ds_read_b64_tr_b16 v[150:151], v16 offset:13312
    s_waitcnt lgkmcnt(8)
    v_mfma_f32_32x32x16_bf16 v[116:131], v[156:159], v[144:147], v[116:131]
    ds_read_b64_tr_b16 v[152:153], v17 offset:12288
    ds_read_b64_tr_b16 v[154:155], v17 offset:13312
    s_waitcnt lgkmcnt(7)
    v_mfma_f32_32x32x16_bf16 v[100:115], v[32:35], v[132:135], v[100:115]
    s_barrier
    v_add_u32 v10, 0x10000, v10
    v_add_u32 v11, 0x10000, v11
    v_add_u32 v12, 0x10000, v12
    v_add_u32 v13, 0x10000, v13
    v_add_u32 v14, 0x10000, v14
    v_add_u32 v15, 0x10000, v15
    v_add_u32 v16, 0x10000, v16
    v_add_u32 v17, 0x10000, v17
    ds_read_b128 v[36:39], v10 offset:32768
    ds_read_b64_tr_b16 v[140:141], v14 offset:32768
    ds_read_b64_tr_b16 v[142:143], v14 offset:33792
    s_waitcnt lgkmcnt(8)
    v_mfma_f32_32x32x16_bf16 v[116:131], v[32:35], v[136:139], v[116:131]
    ds_read_b64_tr_b16 v[144:145], v15 offset:32768
    ds_read_b64_tr_b16 v[146:147], v15 offset:33792
    s_waitcnt lgkmcnt(7)
    v_mfma_f32_32x32x16_bf16 v[100:115], v[160:163], v[148:151], v[100:115]
    ds_read_b128 v[156:159], v11 offset:32768
    ds_read_b64_tr_b16 v[132:133], v16 offset:36864
    ds_read_b64_tr_b16 v[134:135], v16 offset:37888
    s_waitcnt lgkmcnt(8)
    v_mfma_f32_32x32x16_bf16 v[116:131], v[160:163], v[152:155], v[116:131]
    ds_read_b64_tr_b16 v[136:137], v17 offset:36864
    ds_read_b64_tr_b16 v[138:139], v17 offset:37888
    s_waitcnt lgkmcnt(7)
    v_mfma_f32_32x32x16_bf16 v[100:115], v[36:39], v[140:143], v[100:115]
    ds_read_b128 v[40:43], v12 offset:32768
    ds_read_b64_tr_b16 v[148:149], v14 offset:40960
    ds_read_b64_tr_b16 v[150:151], v14 offset:41984
    s_waitcnt lgkmcnt(8)
    v_mfma_f32_32x32x16_bf16 v[116:131], v[36:39], v[144:147], v[116:131]
    ds_read_b64_tr_b16 v[152:153], v15 offset:40960
    ds_read_b64_tr_b16 v[154:155], v15 offset:41984
    s_waitcnt lgkmcnt(7)
    v_mfma_f32_32x32x16_bf16 v[100:115], v[156:159], v[132:135], v[100:115]
    ds_read_b128 v[160:163], v13 offset:32768
    ds_read_b64_tr_b16 v[140:141], v16 offset:45056
    ds_read_b64_tr_b16 v[142:143], v16 offset:46080
    s_waitcnt lgkmcnt(8)
    v_mfma_f32_32x32x16_bf16 v[116:131], v[156:159], v[136:139], v[116:131]
    ds_read_b64_tr_b16 v[144:145], v17 offset:45056
    ds_read_b64_tr_b16 v[146:147], v17 offset:46080
    s_waitcnt lgkmcnt(7)
    v_mfma_f32_32x32x16_bf16 v[100:115], v[40:43], v[148:151], v[100:115]
    s_barrier
    ds_read_b128 v[44:47], v10 offset:0
    ds_read_b64_tr_b16 v[132:133], v14 offset:0
    ds_read_b64_tr_b16 v[134:135], v14 offset:1024
    s_waitcnt lgkmcnt(8)
    v_mfma_f32_32x32x16_bf16 v[116:131], v[40:43], v[152:155], v[116:131]
    ds_read_b64_tr_b16 v[136:137], v15 offset:0
    ds_read_b64_tr_b16 v[138:139], v15 offset:1024
    s_waitcnt lgkmcnt(7)
    v_mfma_f32_32x32x16_bf16 v[100:115], v[160:163], v[140:143], v[100:115]
    ds_read_b128 v[156:159], v11 offset:0
    ds_read_b64_tr_b16 v[148:149], v16 offset:4096
    ds_read_b64_tr_b16 v[150:151], v16 offset:5120
    s_waitcnt lgkmcnt(8)
    v_mfma_f32_32x32x16_bf16 v[116:131], v[160:163], v[144:147], v[116:131]
    ds_read_b64_tr_b16 v[152:153], v17 offset:4096
    ds_read_b64_tr_b16 v[154:155], v17 offset:5120
    s_waitcnt lgkmcnt(7)
    v_mfma_f32_32x32x16_bf16 v[100:115], v[44:47], v[132:135], v[100:115]
    ds_read_b128 v[48:51], v12 offset:0
    ds_read_b64_tr_b16 v[140:141], v14 offset:8192
    ds_read_b64_tr_b16 v[142:143], v14 offset:9216
    s_waitcnt lgkmcnt(8)
    v_mfma_f32_32x32x16_bf16 v[116:131], v[44:47], v[136:139], v[116:131]
    ds_read_b64_tr_b16 v[144:145], v15 offset:8192
    ds_read_b64_tr_b16 v[146:147], v15 offset:9216
    s_waitcnt lgkmcnt(7)
    v_mfma_f32_32x32x16_bf16 v[100:115], v[156:159], v[148:151], v[100:115]
    ds_read_b128 v[160:163], v13 offset:0
    ds_read_b64_tr_b16 v[132:133], v16 offset:12288
    ds_read_b64_tr_b16 v[134:135], v16 offset:13312
    s_waitcnt lgkmcnt(8)
    v_mfma_f32_32x32x16_bf16 v[116:131], v[156:159], v[152:155], v[116:131]
    ds_read_b64_tr_b16 v[136:137], v17 offset:12288
    ds_read_b64_tr_b16 v[138:139], v17 offset:13312
    s_waitcnt lgkmcnt(7)
    v_mfma_f32_32x32x16_bf16 v[100:115], v[48:51], v[140:143], v[100:115]
    s_barrier
    v_add_u32 v10, 0xffff0000, v10
    v_add_u32 v11, 0xffff0000, v11
    v_add_u32 v12, 0xffff0000, v12
    v_add_u32 v13, 0xffff0000, v13
    v_add_u32 v14, 0xffff0000, v14
    v_add_u32 v15, 0xffff0000, v15
    v_add_u32 v16, 0xffff0000, v16
    v_add_u32 v17, 0xffff0000, v17
    ds_read_b128 v[52:55], v10 offset:32768
    ds_read_b64_tr_b16 v[148:149], v14 offset:32768
    ds_read_b64_tr_b16 v[150:151], v14 offset:33792
    s_waitcnt lgkmcnt(8)
    v_mfma_f32_32x32x16_bf16 v[116:131], v[48:51], v[144:147], v[116:131]
    ds_read_b64_tr_b16 v[152:153], v15 offset:32768
    ds_read_b64_tr_b16 v[154:155], v15 offset:33792
    s_waitcnt lgkmcnt(7)
    v_mfma_f32_32x32x16_bf16 v[100:115], v[160:163], v[132:135], v[100:115]
    ds_read_b128 v[156:159], v11 offset:32768
    ds_read_b64_tr_b16 v[140:141], v16 offset:36864
    ds_read_b64_tr_b16 v[142:143], v16 offset:37888
    s_waitcnt lgkmcnt(8)
    v_mfma_f32_32x32x16_bf16 v[116:131], v[160:163], v[136:139], v[116:131]
    ds_read_b64_tr_b16 v[144:145], v17 offset:36864
    ds_read_b64_tr_b16 v[146:147], v17 offset:37888
    s_waitcnt lgkmcnt(7)
    v_mfma_f32_32x32x16_bf16 v[100:115], v[52:55], v[148:151], v[100:115]
    ds_read_b128 v[56:59], v12 offset:32768
    ds_read_b64_tr_b16 v[132:133], v14 offset:40960
    ds_read_b64_tr_b16 v[134:135], v14 offset:41984
    s_waitcnt lgkmcnt(8)
    v_mfma_f32_32x32x16_bf16 v[116:131], v[52:55], v[152:155], v[116:131]
    ds_read_b64_tr_b16 v[136:137], v15 offset:40960
    ds_read_b64_tr_b16 v[138:139], v15 offset:41984
    s_waitcnt lgkmcnt(7)
    v_mfma_f32_32x32x16_bf16 v[100:115], v[156:159], v[140:143], v[100:115]
    ds_read_b128 v[160:163], v13 offset:32768
    ds_read_b64_tr_b16 v[148:149], v16 offset:45056
    ds_read_b64_tr_b16 v[150:151], v16 offset:46080
    s_waitcnt lgkmcnt(8)
    v_mfma_f32_32x32x16_bf16 v[116:131], v[156:159], v[144:147], v[116:131]
    ds_read_b64_tr_b16 v[152:153], v17 offset:45056
    ds_read_b64_tr_b16 v[154:155], v17 offset:46080
    s_waitcnt lgkmcnt(7)
    v_mfma_f32_32x32x16_bf16 v[100:115], v[56:59], v[132:135], v[100:115]
    s_barrier
    ds_read_b128 v[60:63], v10 offset:0
    ds_read_b64_tr_b16 v[140:141], v14 offset:0
    ds_read_b64_tr_b16 v[142:143], v14 offset:1024
    s_waitcnt lgkmcnt(8)
    v_mfma_f32_32x32x16_bf16 v[116:131], v[56:59], v[136:139], v[116:131]
    ds_read_b64_tr_b16 v[144:145], v15 offset:0
    ds_read_b64_tr_b16 v[146:147], v15 offset:1024
    s_waitcnt lgkmcnt(7)
    v_mfma_f32_32x32x16_bf16 v[100:115], v[160:163], v[148:151], v[100:115]
    ds_read_b128 v[156:159], v11 offset:0
    ds_read_b64_tr_b16 v[132:133], v16 offset:4096
    ds_read_b64_tr_b16 v[134:135], v16 offset:5120
    s_waitcnt lgkmcnt(8)
    v_mfma_f32_32x32x16_bf16 v[116:131], v[160:163], v[152:155], v[116:131]
    ds_read_b64_tr_b16 v[136:137], v17 offset:4096
    ds_read_b64_tr_b16 v[138:139], v17 offset:5120
    s_waitcnt lgkmcnt(7)
    v_mfma_f32_32x32x16_bf16 v[100:115], v[60:63], v[140:143], v[100:115]
    ds_read_b128 v[64:67], v12 offset:0
    ds_read_b64_tr_b16 v[148:149], v14 offset:8192
    ds_read_b64_tr_b16 v[150:151], v14 offset:9216
    s_waitcnt lgkmcnt(8)
    v_mfma_f32_32x32x16_bf16 v[116:131], v[60:63], v[144:147], v[116:131]
    ds_read_b64_tr_b16 v[152:153], v15 offset:8192
    ds_read_b64_tr_b16 v[154:155], v15 offset:9216
    s_waitcnt lgkmcnt(7)
    v_mfma_f32_32x32x16_bf16 v[100:115], v[156:159], v[132:135], v[100:115]
    ds_read_b128 v[160:163], v13 offset:0
    ds_read_b64_tr_b16 v[140:141], v16 offset:12288
    ds_read_b64_tr_b16 v[142:143], v16 offset:13312
    s_waitcnt lgkmcnt(8)
    v_mfma_f32_32x32x16_bf16 v[116:131], v[156:159], v[136:139], v[116:131]
    ds_read_b64_tr_b16 v[144:145], v17 offset:12288
    ds_read_b64_tr_b16 v[146:147], v17 offset:13312
    s_waitcnt lgkmcnt(7)
    v_mfma_f32_32x32x16_bf16 v[100:115], v[64:67], v[148:151], v[100:115]
    s_barrier
    v_add_u32 v10, 0x10000, v10
    v_add_u32 v11, 0x10000, v11
    v_add_u32 v12, 0x10000, v12
    v_add_u32 v13, 0x10000, v13
    v_add_u32 v14, 0x10000, v14
    v_add_u32 v15, 0x10000, v15
    v_add_u32 v16, 0x10000, v16
    v_add_u32 v17, 0x10000, v17
    ds_read_b128 v[68:71], v10 offset:32768
    ds_read_b64_tr_b16 v[132:133], v14 offset:32768
    ds_read_b64_tr_b16 v[134:135], v14 offset:33792
    s_waitcnt lgkmcnt(8)
    v_mfma_f32_32x32x16_bf16 v[116:131], v[64:67], v[152:155], v[116:131]
    ds_read_b64_tr_b16 v[136:137], v15 offset:32768
    ds_read_b64_tr_b16 v[138:139], v15 offset:33792
    s_waitcnt lgkmcnt(7)
    v_mfma_f32_32x32x16_bf16 v[100:115], v[160:163], v[140:143], v[100:115]
    ds_read_b128 v[156:159], v11 offset:32768
    ds_read_b64_tr_b16 v[148:149], v16 offset:36864
    ds_read_b64_tr_b16 v[150:151], v16 offset:37888
    s_waitcnt lgkmcnt(8)
    v_mfma_f32_32x32x16_bf16 v[116:131], v[160:163], v[144:147], v[116:131]
    ds_read_b64_tr_b16 v[152:153], v17 offset:36864
    ds_read_b64_tr_b16 v[154:155], v17 offset:37888
    s_waitcnt lgkmcnt(7)
    v_mfma_f32_32x32x16_bf16 v[100:115], v[68:71], v[132:135], v[100:115]
    ds_read_b128 v[72:75], v12 offset:32768
    ds_read_b64_tr_b16 v[140:141], v14 offset:40960
    ds_read_b64_tr_b16 v[142:143], v14 offset:41984
    s_waitcnt lgkmcnt(8)
    v_mfma_f32_32x32x16_bf16 v[116:131], v[68:71], v[136:139], v[116:131]
    ds_read_b64_tr_b16 v[144:145], v15 offset:40960
    ds_read_b64_tr_b16 v[146:147], v15 offset:41984
    s_waitcnt lgkmcnt(7)
    v_mfma_f32_32x32x16_bf16 v[100:115], v[156:159], v[148:151], v[100:115]
    ds_read_b128 v[160:163], v13 offset:32768
    ds_read_b64_tr_b16 v[132:133], v16 offset:45056
    ds_read_b64_tr_b16 v[134:135], v16 offset:46080
    s_waitcnt lgkmcnt(8)
    v_mfma_f32_32x32x16_bf16 v[116:131], v[156:159], v[152:155], v[116:131]
    ds_read_b64_tr_b16 v[136:137], v17 offset:45056
    ds_read_b64_tr_b16 v[138:139], v17 offset:46080
    s_waitcnt lgkmcnt(7)
    v_mfma_f32_32x32x16_bf16 v[100:115], v[72:75], v[140:143], v[100:115]
    s_barrier
    ds_read_b128 v[76:79], v10 offset:0
    ds_read_b64_tr_b16 v[148:149], v14 offset:0
    ds_read_b64_tr_b16 v[150:151], v14 offset:1024
    s_waitcnt lgkmcnt(8)
    v_mfma_f32_32x32x16_bf16 v[116:131], v[72:75], v[144:147], v[116:131]
    ds_read_b64_tr_b16 v[152:153], v15 offset:0
    ds_read_b64_tr_b16 v[154:155], v15 offset:1024
    s_waitcnt lgkmcnt(7)
    v_mfma_f32_32x32x16_bf16 v[100:115], v[160:163], v[132:135], v[100:115]
    ds_read_b128 v[156:159], v11 offset:0
    ds_read_b64_tr_b16 v[140:141], v16 offset:4096
    ds_read_b64_tr_b16 v[142:143], v16 offset:5120
    s_waitcnt lgkmcnt(8)
    v_mfma_f32_32x32x16_bf16 v[116:131], v[160:163], v[136:139], v[116:131]
    ds_read_b64_tr_b16 v[144:145], v17 offset:4096
    ds_read_b64_tr_b16 v[146:147], v17 offset:5120
    s_waitcnt lgkmcnt(7)
    v_mfma_f32_32x32x16_bf16 v[100:115], v[76:79], v[148:151], v[100:115]
    ds_read_b128 v[80:83], v12 offset:0
    ds_read_b64_tr_b16 v[132:133], v14 offset:8192
    ds_read_b64_tr_b16 v[134:135], v14 offset:9216
    s_waitcnt lgkmcnt(8)
    v_mfma_f32_32x32x16_bf16 v[116:131], v[76:79], v[152:155], v[116:131]
    ds_read_b64_tr_b16 v[136:137], v15 offset:8192
    ds_read_b64_tr_b16 v[138:139], v15 offset:9216
    s_waitcnt lgkmcnt(7)
    v_mfma_f32_32x32x16_bf16 v[100:115], v[156:159], v[140:143], v[100:115]
    ds_read_b128 v[160:163], v13 offset:0
    ds_read_b64_tr_b16 v[148:149], v16 offset:12288
    ds_read_b64_tr_b16 v[150:151], v16 offset:13312
    s_waitcnt lgkmcnt(8)
    v_mfma_f32_32x32x16_bf16 v[116:131], v[156:159], v[144:147], v[116:131]
    ds_read_b64_tr_b16 v[152:153], v17 offset:12288
    ds_read_b64_tr_b16 v[154:155], v17 offset:13312
    s_waitcnt lgkmcnt(7)
    v_mfma_f32_32x32x16_bf16 v[100:115], v[80:83], v[132:135], v[100:115]
    s_waitcnt vmcnt(0)
    s_barrier
    v_add_u32 v10, 0xffff0000, v10
    v_add_u32 v11, 0xffff0000, v11
    v_add_u32 v12, 0xffff0000, v12
    v_add_u32 v13, 0xffff0000, v13
    v_add_u32 v14, 0xffff0000, v14
    v_add_u32 v15, 0xffff0000, v15
    v_add_u32 v16, 0xffff0000, v16
    v_add_u32 v17, 0xffff0000, v17
    ds_read_b128 v[84:87], v10 offset:32768
    ds_read_b64_tr_b16 v[140:141], v14 offset:32768
    ds_read_b64_tr_b16 v[142:143], v14 offset:33792
    s_waitcnt lgkmcnt(8)
    v_mfma_f32_32x32x16_bf16 v[116:131], v[80:83], v[136:139], v[116:131]
    ds_read_b64_tr_b16 v[144:145], v15 offset:32768
    ds_read_b64_tr_b16 v[146:147], v15 offset:33792
    s_waitcnt lgkmcnt(7)
    v_mfma_f32_32x32x16_bf16 v[100:115], v[160:163], v[148:151], v[100:115]
    ds_read_b128 v[156:159], v11 offset:32768
    ds_read_b64_tr_b16 v[132:133], v16 offset:36864
    ds_read_b64_tr_b16 v[134:135], v16 offset:37888
    s_waitcnt lgkmcnt(8)
    v_mfma_f32_32x32x16_bf16 v[116:131], v[160:163], v[152:155], v[116:131]
    ds_read_b64_tr_b16 v[136:137], v17 offset:36864
    ds_read_b64_tr_b16 v[138:139], v17 offset:37888
    s_waitcnt lgkmcnt(7)
    v_mfma_f32_32x32x16_bf16 v[100:115], v[84:87], v[140:143], v[100:115]
    ds_read_b128 v[88:91], v12 offset:32768
    ds_read_b64_tr_b16 v[148:149], v14 offset:40960
    ds_read_b64_tr_b16 v[150:151], v14 offset:41984
    s_waitcnt lgkmcnt(8)
    v_mfma_f32_32x32x16_bf16 v[116:131], v[84:87], v[144:147], v[116:131]
    ds_read_b64_tr_b16 v[152:153], v15 offset:40960
    ds_read_b64_tr_b16 v[154:155], v15 offset:41984
    s_waitcnt lgkmcnt(7)
    v_mfma_f32_32x32x16_bf16 v[100:115], v[156:159], v[132:135], v[100:115]
    ds_read_b128 v[160:163], v13 offset:32768
    ds_read_b64_tr_b16 v[140:141], v16 offset:45056
    ds_read_b64_tr_b16 v[142:143], v16 offset:46080
    s_waitcnt lgkmcnt(8)
    v_mfma_f32_32x32x16_bf16 v[116:131], v[156:159], v[136:139], v[116:131]
    ds_read_b64_tr_b16 v[144:145], v17 offset:45056
    ds_read_b64_tr_b16 v[146:147], v17 offset:46080
    s_waitcnt lgkmcnt(7)
    v_mfma_f32_32x32x16_bf16 v[100:115], v[88:91], v[148:151], v[100:115]
    s_barrier
    ds_read_b128 v[92:95], v10 offset:0
    ds_read_b64_tr_b16 v[132:133], v14 offset:0
    ds_read_b64_tr_b16 v[134:135], v14 offset:1024
    s_waitcnt lgkmcnt(8)
    v_mfma_f32_32x32x16_bf16 v[116:131], v[88:91], v[152:155], v[116:131]
    ds_read_b64_tr_b16 v[136:137], v15 offset:0
    ds_read_b64_tr_b16 v[138:139], v15 offset:1024
    s_waitcnt lgkmcnt(7)
    v_mfma_f32_32x32x16_bf16 v[100:115], v[160:163], v[140:143], v[100:115]
    ds_read_b128 v[156:159], v11 offset:0
    ds_read_b64_tr_b16 v[148:149], v16 offset:4096
    ds_read_b64_tr_b16 v[150:151], v16 offset:5120
    s_waitcnt lgkmcnt(8)
    v_mfma_f32_32x32x16_bf16 v[116:131], v[160:163], v[144:147], v[116:131]
    ds_read_b64_tr_b16 v[152:153], v17 offset:4096
    ds_read_b64_tr_b16 v[154:155], v17 offset:5120
    s_waitcnt lgkmcnt(7)
    v_mfma_f32_32x32x16_bf16 v[100:115], v[92:95], v[132:135], v[100:115]
    ds_read_b128 v[96:99], v12 offset:0
    ds_read_b64_tr_b16 v[140:141], v14 offset:8192
    ds_read_b64_tr_b16 v[142:143], v14 offset:9216
    s_waitcnt lgkmcnt(8)
    v_mfma_f32_32x32x16_bf16 v[116:131], v[92:95], v[136:139], v[116:131]
    ds_read_b64_tr_b16 v[144:145], v15 offset:8192
    ds_read_b64_tr_b16 v[146:147], v15 offset:9216
    s_waitcnt lgkmcnt(7)
    v_mfma_f32_32x32x16_bf16 v[100:115], v[156:159], v[148:151], v[100:115]
    ds_read_b128 v[160:163], v13 offset:0
    ds_read_b64_tr_b16 v[132:133], v16 offset:12288
    ds_read_b64_tr_b16 v[134:135], v16 offset:13312
    s_waitcnt lgkmcnt(8)
    v_mfma_f32_32x32x16_bf16 v[116:131], v[156:159], v[152:155], v[116:131]
    ds_read_b64_tr_b16 v[136:137], v17 offset:12288
    ds_read_b64_tr_b16 v[138:139], v17 offset:13312
    s_waitcnt lgkmcnt(7)
    v_mfma_f32_32x32x16_bf16 v[100:115], v[96:99], v[140:143], v[100:115]
    s_barrier
    ds_read_b64_tr_b16 v[148:149], v18 offset:61440
    ds_read_b64_tr_b16 v[150:151], v18 offset:61952
    s_waitcnt lgkmcnt(7)
    v_mfma_f32_32x32x16_bf16 v[116:131], v[96:99], v[144:147], v[116:131]
    ds_read_b64_tr_b16 v[152:153], v18 offset:57344
    ds_read_b64_tr_b16 v[154:155], v18 offset:57856
    s_waitcnt lgkmcnt(6)
    v_mfma_f32_32x32x16_bf16 v[100:115], v[160:163], v[132:135], v[100:115]
    ds_read_b64_tr_b16 v[156:157], v1 offset:61440
    ds_read_b64_tr_b16 v[158:159], v1 offset:61952
    s_waitcnt lgkmcnt(6)
    v_mfma_f32_32x32x16_bf16 v[116:131], v[160:163], v[136:139], v[116:131]
    ds_read_b64_tr_b16 v[164:165], v1 offset:57344
    ds_read_b64_tr_b16 v[166:167], v1 offset:57856
KF_LAST:
    s_branch KF_P2
.section .rodata,"a"
.p2align 6
.amdhsa_kernel fused_kernel
  .amdhsa_next_free_vgpr 168
  .amdhsa_next_free_sgpr 102
  .amdhsa_accum_offset 168
  .amdhsa_group_segment_fixed_size 0
  .amdhsa_kernarg_size 80
  .amdhsa_user_sgpr_count 2
  .amdhsa_user_sgpr_kernarg_segment_ptr 1
  .amdhsa_system_sgpr_workgroup_id_x 1
.end_amdhsa_kernel
```
